```python
import torch

def _softmax(x, axis=-1):
    return torch.softmax(x, dim=axis)
def _gelu(x):
    return torch.nn.functional.gelu(x, approximate="tanh")
def _silu(x):
    return torch.nn.functional.silu(x)
def _sigmoid(x):
    return torch.sigmoid(x)
def _layernorm(x, axis=-1, eps=1e-5):
    m = x.mean(dim=axis, keepdim=True)
    v = x.var(dim=axis, keepdim=True, unbiased=False)
    return (x - m) / torch.sqrt(v + eps)
def _scatter_add(tgt, idx, src, axis=0):
    return tgt.clone().index_add_(axis, idx, src)
def _segment_sum(src, seg, n):
    out = torch.zeros((n,) + src.shape[1:], dtype=src.dtype)
    return out.index_add_(0, seg, src)
def _pad(x, pw):
    flat = tuple(v for pair in reversed(pw) for v in pair)
    return torch.nn.functional.pad(x, flat)

kernel_name = 'standalone__gqa_softmax__near_ridge'

def setup_inputs():

    _w = (lambda a: (lambda t: t.to(torch.bfloat16) if t.is_floating_point() else t)(torch.as_tensor(a)))
    B, Hq, Hkv, Sq, Sk, D = 8, 32, 8, 384, 512, 128
    return {
        "q": _w((lambda *s: torch.randn(*s, dtype=torch.bfloat16) * 0.8)(B, Hq, Sq, D)),
        "k": _w((lambda *s: torch.randn(*s, dtype=torch.bfloat16) * 0.8)(B, Hkv, Sk, D)),
        "v": _w((lambda *s: torch.randn(*s, dtype=torch.bfloat16) * 0.05)(B, Hkv, Sk, D)),
    }

def reference(q, k, v):
    B, Hq, Sq, D = q.shape
    Hkv = k.shape[1]
    rep = Hq // Hkv
    k = (lambda x, n, axis: torch.repeat_interleave(x, n, dim=axis))(k, rep, axis=1)
    v = (lambda x, n, axis: torch.repeat_interleave(x, n, dim=axis))(v, rep, axis=1)
    scale = D ** -0.5
    scores = torch.einsum("bhqd,bhkd->bhqk", q, k) * scale
    p = _softmax(scores, axis=-1)
    return torch.einsum("bhqk,bhkd->bhqd", p, v)
```

```asm
; @launch grid=(256,1,1) block=(256,1,1) lds=149504
.amdgcn_target "amdgcn-amd-amdhsa--gfx950"
.text
.globl standalone__gqa_softmax__near_ridge_kernel
.p2align 8
.type standalone__gqa_softmax__near_ridge_kernel,@function
standalone__gqa_softmax__near_ridge_kernel:
    s_cmp_ge_u32 s2, 256
    s_cbranch_scc1 Lend
    s_load_dwordx8 s[4:11], s[0:1], 0
    v_lshrrev_b32 v41, 6, v0
    v_and_b32 v40, 63, v0
    v_readfirstlane_b32 s32, v41
    v_lshlrev_b32 v1, 4, v40
    s_and_b32 s74, s2, 7
    s_lshr_b32 s75, s2, 3
    s_lshl_b32 s74, s74, 3
    s_lshr_b32 s76, s75, 2
    s_add_u32 s74, s74, s76
    s_and_b32 s75, s75, 3
    s_lshl_b32 s76, s74, 2
    s_add_u32 s76, s76, s75
    s_mul_i32 s76, s76, 98304
    s_lshl_b32 s74, s74, 17
    v_lshrrev_b32 v42, 4, v40
    v_lshl_add_u32 v43, v41, 3, v42
    v_and_b32 v44, 15, v40
    v_xor_b32 v3, v44, v43
    v_and_b32 v3, 15, v3
    v_lshlrev_b32 v43, 8, v43
    v_lshl_add_u32 v2, v3, 4, v43
    v_xor_b32 v3, 64, v2
    s_lshl_b32 s33, s32, 11
    s_lshl_b32 s56, s32, 12
    s_add_u32 s57, s56, 16384
    s_mov_b32 s40, 0
    s_mov_b32 s41, 8192
    s_mov_b32 s18, 131072
    s_mov_b32 s19, 0x20000
    s_mov_b32 s14, 98304
    s_mov_b32 s15, 0x20000
    s_waitcnt lgkmcnt(0)
    s_add_u32 s16, s6, s74
    s_addc_u32 s17, s7, 0
    s_add_u32 s12, s4, s76
    s_addc_u32 s13, s5, 0
    s_add_u32 m0, s33, 0
    s_nop 0
    buffer_load_dwordx4 v2, s[16:19], s40 offen offset:0 nt lds
    buffer_load_dwordx4 v3, s[16:19], s40 offen offset:1024 nt lds
    buffer_load_dwordx4 v[240:243], v1, s[12:15], s56 offen offset:0 nt
    buffer_load_dwordx4 v[244:247], v1, s[12:15], s56 offen offset:1024 nt
    buffer_load_dwordx4 v[248:251], v1, s[12:15], s56 offen offset:2048 nt
    buffer_load_dwordx4 v[252:255], v1, s[12:15], s56 offen offset:3072 nt
    buffer_load_dwordx4 v[96:99], v1, s[12:15], s57 offen offset:0 nt
    buffer_load_dwordx4 v[100:103], v1, s[12:15], s57 offen offset:1024 nt
    buffer_load_dwordx4 v[104:107], v1, s[12:15], s57 offen offset:2048 nt
    buffer_load_dwordx4 v[108:111], v1, s[12:15], s57 offen offset:3072 nt
    s_add_u32 s20, s8, s74
    s_addc_u32 s21, s9, 0
    s_mov_b32 s22, 131072
    s_mov_b32 s23, 0x20000
    s_add_u32 s34, s33, 49152
    v_lshlrev_b32 v4, 1, v42
    v_xor_b32 v4, v4, v44
    v_lshl_add_u32 v4, v4, 4, v43
    v_xor_b32 v5, 128, v4
    s_add_u32 m0, s34, 0
    s_nop 0
    buffer_load_dwordx4 v4, s[20:23], s40 offen offset:0 nt lds
    buffer_load_dwordx4 v5, s[20:23], s40 offen offset:1024 nt lds
    s_add_u32 m0, s33, 8192
    s_nop 0
    buffer_load_dwordx4 v2, s[16:19], s41 offen offset:0 nt lds
    buffer_load_dwordx4 v3, s[16:19], s41 offen offset:1024 nt lds
    s_getpc_b64 s[28:29]
Lpc:
    s_mov_b32 s30, Lcode_end-Lpc
    s_mov_b32 s31, 0x20000
    s_bfe_u32 s77, s2, 0x20003
    s_lshl_b32 s77, s77, 2
    s_add_u32 s77, s77, s32
    s_mul_i32 s77, s77, 2048
    buffer_load_dwordx4 a[220:223], v1, s[28:31], s77 offen offset:0
    buffer_load_dwordx4 a[220:223], v1, s[28:31], s77 offen offset:1024
    s_add_u32 s24, s10, s76
    s_addc_u32 s25, s11, 0
    s_mov_b32 s26, 98304
    s_mov_b32 s27, 0x20000
    s_mov_b32 s35, 0x3e0293ee
    s_mov_b32 s36, 0xffff0000
    s_mov_b32 s37, 0xbe0293ee
    s_mov_b32 s3, 0x58800000
    s_mov_b32 s42, 16384
    s_mov_b32 s43, 24576
    s_mov_b32 s44, 32768
    s_mov_b32 s45, 40960
    s_mov_b32 s46, 49152
    s_mov_b32 s47, 57344
    s_mov_b32 s48, 65536
    s_mov_b32 s49, 73728
    s_mov_b32 s50, 81920
    s_mov_b32 s51, 90112
    s_mov_b32 s52, 98304
    s_mov_b32 s53, 106496
    s_mov_b32 s54, 114688
    s_mov_b32 s55, 122880
    s_add_u32 s58, s56, 32768
    s_add_u32 s59, s56, 49152
    s_add_u32 s60, s56, 65536
    s_add_u32 s61, s56, 81920
    s_mul_i32 s39, s32, 12800
    s_add_u32 s39, s39, 98304
    v_xor_b32 v92, v42, v44
    v_lshlrev_b32 v92, 4, v92
    v_lshl_add_u32 v92, v42, 8, v92
    v_xor_b32 v93, 64, v92
    v_xor_b32 v94, 128, v92
    v_xor_b32 v95, 192, v92
    s_mov_b32 s77, 272
    v_bfe_u32 v45, v40, 2, 2
    v_and_b32 v46, 3, v40
    v_mul_u32_u24 v6, s77, v42
    v_lshl_add_u32 v6, v44, 4, v6
    v_add_u32 v6, s39, v6
    v_mul_u32_u24 v8, s77, v44
    v_add_u32 v8, s39, v8
    v_lshl_add_u32 v7, v42, 4, v8
    v_lshl_add_u32 v8, v42, 3, v8
    v_xor_b32 v9, v42, v44
    v_lshlrev_b32 v9, 4, v9
    v_lshl_add_u32 v9, v44, 8, v9
    v_xor_b32 v10, 64, v9
    v_xor_b32 v11, 128, v9
    v_xor_b32 v12, 192, v9
    v_add_u32 v0, s39, v9
    v_add_u32 v21, s39, v10
    v_add_u32 v26, s39, v11
    v_add_u32 v27, s39, v12
    v_lshl_add_u32 v43, v42, 2, v45
    v_lshlrev_b32 v13, 8, v43
    v_and_b32 v43, 7, v43
    v_lshl_add_u32 v13, v43, 5, v13
    v_lshl_add_u32 v13, v46, 3, v13
    v_add_u32 v13, 49152, v13
    v_xor_b32 v14, 32, v13
    v_xor_b32 v15, 64, v13
    v_xor_b32 v16, 96, v13
    v_xor_b32 v17, 128, v13
    v_xor_b32 v18, 160, v13
    v_xor_b32 v19, 192, v13
    v_xor_b32 v20, 224, v13
    v_cmp_eq_u32 vcc, 0, v46
    v_mov_b32 v43, 0x3f803f80
    s_nop 0
    v_cndmask_b32 v43, 0, v43, vcc
    v_accvgpr_write_b32 a216, v43
    v_accvgpr_write_b32 a217, v43
    v_accvgpr_write_b32 a218, v43
    v_accvgpr_write_b32 a219, v43
    s_waitcnt vmcnt(14)
    s_barrier
    ds_read_b128 a[128:131], v9 offset:0
    ds_read_b128 a[132:135], v10 offset:0
    ds_read_b128 a[136:139], v11 offset:0
    ds_read_b128 a[140:143], v12 offset:0
    ds_read_b128 a[144:147], v9 offset:4096
    ds_read_b128 a[148:151], v10 offset:4096
    ds_read_b128 a[152:155], v11 offset:4096
    ds_read_b128 a[156:159], v12 offset:4096
    s_waitcnt vmcnt(13)
    v_lshlrev_b32 v22, 16, v240
    s_add_u32 m0, s33, 16384
    s_nop 0
    buffer_load_dwordx4 v2, s[16:19], s42 offen offset:0 nt lds
    v_and_b32 v23, s36, v240
    v_pk_mul_f32 v[22:23], v[22:23], s[34:35] op_sel:[0,1] op_sel_hi:[1,1]
    v_cvt_pk_bf16_f32 v240, v22, v23
    v_lshlrev_b32 v24, 16, v241
    v_and_b32 v25, s36, v241
    v_pk_mul_f32 v[24:25], v[24:25], s[34:35] op_sel:[0,1] op_sel_hi:[1,1]
    v_cvt_pk_bf16_f32 v241, v24, v25
    ds_write_b64 v6, v[240:241] offset:0
    v_lshlrev_b32 v22, 16, v242
    v_and_b32 v23, s36, v242
    v_pk_mul_f32 v[22:23], v[22:23], s[34:35] op_sel:[0,1] op_sel_hi:[1,1]
    v_cvt_pk_bf16_f32 v242, v22, v23
    v_lshlrev_b32 v24, 16, v243
    v_and_b32 v25, s36, v243
    v_pk_mul_f32 v[24:25], v[24:25], s[34:35] op_sel:[0,1] op_sel_hi:[1,1]
    v_cvt_pk_bf16_f32 v243, v24, v25
    ds_write_b64 v6, v[242:243] offset:8
    s_waitcnt vmcnt(13)
    v_lshlrev_b32 v22, 16, v244
    buffer_load_dwordx4 v3, s[16:19], s42 offen offset:1024 nt lds
    v_and_b32 v23, s36, v244
    v_pk_mul_f32 v[22:23], v[22:23], s[34:35] op_sel:[0,1] op_sel_hi:[1,1]
    v_cvt_pk_bf16_f32 v244, v22, v23
    v_lshlrev_b32 v24, 16, v245
    v_and_b32 v25, s36, v245
    v_pk_mul_f32 v[24:25], v[24:25], s[34:35] op_sel:[0,1] op_sel_hi:[1,1]
    v_cvt_pk_bf16_f32 v245, v24, v25
    ds_write_b64 v6, v[244:245] offset:1088
    v_lshlrev_b32 v22, 16, v246
    v_and_b32 v23, s36, v246
    v_pk_mul_f32 v[22:23], v[22:23], s[34:35] op_sel:[0,1] op_sel_hi:[1,1]
    v_cvt_pk_bf16_f32 v246, v22, v23
    v_lshlrev_b32 v24, 16, v247
    v_and_b32 v25, s36, v247
    v_pk_mul_f32 v[24:25], v[24:25], s[34:35] op_sel:[0,1] op_sel_hi:[1,1]
    v_cvt_pk_bf16_f32 v247, v24, v25
    ds_write_b64 v6, v[246:247] offset:1096
    s_waitcnt vmcnt(13)
    v_lshlrev_b32 v22, 16, v248
    s_add_u32 m0, s34, 8192
    s_nop 0
    buffer_load_dwordx4 v4, s[20:23], s41 offen offset:0 nt lds
    v_and_b32 v23, s36, v248
    v_pk_mul_f32 v[22:23], v[22:23], s[34:35] op_sel:[0,1] op_sel_hi:[1,1]
    v_cvt_pk_bf16_f32 v248, v22, v23
    v_lshlrev_b32 v24, 16, v249
    v_and_b32 v25, s36, v249
    v_pk_mul_f32 v[24:25], v[24:25], s[34:35] op_sel:[0,1] op_sel_hi:[1,1]
    v_cvt_pk_bf16_f32 v249, v24, v25
    ds_write_b64 v6, v[248:249] offset:2176
    v_lshlrev_b32 v22, 16, v250
    v_and_b32 v23, s36, v250
    v_pk_mul_f32 v[22:23], v[22:23], s[34:35] op_sel:[0,1] op_sel_hi:[1,1]
    v_cvt_pk_bf16_f32 v250, v22, v23
    v_lshlrev_b32 v24, 16, v251
    v_and_b32 v25, s36, v251
    v_pk_mul_f32 v[24:25], v[24:25], s[34:35] op_sel:[0,1] op_sel_hi:[1,1]
    v_cvt_pk_bf16_f32 v251, v24, v25
    ds_write_b64 v6, v[250:251] offset:2184
    s_waitcnt vmcnt(13)
    v_lshlrev_b32 v22, 16, v252
    buffer_load_dwordx4 v5, s[20:23], s41 offen offset:1024 nt lds
    v_and_b32 v23, s36, v252
    v_pk_mul_f32 v[22:23], v[22:23], s[34:35] op_sel:[0,1] op_sel_hi:[1,1]
    v_cvt_pk_bf16_f32 v252, v22, v23
    v_lshlrev_b32 v24, 16, v253
    v_and_b32 v25, s36, v253
    v_pk_mul_f32 v[24:25], v[24:25], s[34:35] op_sel:[0,1] op_sel_hi:[1,1]
    v_cvt_pk_bf16_f32 v253, v24, v25
    ds_write_b64 v6, v[252:253] offset:3264
    v_lshlrev_b32 v22, 16, v254
    v_and_b32 v23, s36, v254
    v_pk_mul_f32 v[22:23], v[22:23], s[34:35] op_sel:[0,1] op_sel_hi:[1,1]
    v_cvt_pk_bf16_f32 v254, v22, v23
    v_lshlrev_b32 v24, 16, v255
    v_and_b32 v25, s36, v255
    v_pk_mul_f32 v[24:25], v[24:25], s[34:35] op_sel:[0,1] op_sel_hi:[1,1]
    v_cvt_pk_bf16_f32 v255, v24, v25
    ds_write_b64 v6, v[254:255] offset:3272
    ds_read_b128 a[32:35], v7 offset:0
    ds_read_b128 a[36:39], v7 offset:64
    ds_read_b128 a[40:43], v7 offset:128
    ds_read_b128 a[44:47], v7 offset:192
    s_waitcnt vmcnt(13)
    v_lshlrev_b32 v22, 16, v96
    s_add_u32 m0, s39, 8704
    s_nop 0
    buffer_load_dwordx4 v92, s[12:15], s58 offen offset:0 nt lds
    v_and_b32 v23, s36, v96
    v_pk_mul_f32 v[22:23], v[22:23], s[34:35] op_sel:[0,1] op_sel_hi:[1,1]
    v_cvt_pk_bf16_f32 v96, v22, v23
    v_lshlrev_b32 v24, 16, v97
    v_and_b32 v25, s36, v97
    v_pk_mul_f32 v[24:25], v[24:25], s[34:35] op_sel:[0,1] op_sel_hi:[1,1]
    v_cvt_pk_bf16_f32 v97, v24, v25
    ds_write_b64 v6, v[96:97] offset:4352
    v_lshlrev_b32 v22, 16, v98
    v_and_b32 v23, s36, v98
    v_pk_mul_f32 v[22:23], v[22:23], s[34:35] op_sel:[0,1] op_sel_hi:[1,1]
    v_cvt_pk_bf16_f32 v98, v22, v23
    v_lshlrev_b32 v24, 16, v99
    v_and_b32 v25, s36, v99
    v_pk_mul_f32 v[24:25], v[24:25], s[34:35] op_sel:[0,1] op_sel_hi:[1,1]
    v_cvt_pk_bf16_f32 v99, v24, v25
    ds_write_b64 v6, v[98:99] offset:4360
    s_waitcnt vmcnt(13)
    v_lshlrev_b32 v22, 16, v100
    buffer_load_dwordx4 v93, s[12:15], s58 offen offset:1024 nt lds
    v_and_b32 v23, s36, v100
    v_pk_mul_f32 v[22:23], v[22:23], s[34:35] op_sel:[0,1] op_sel_hi:[1,1]
    v_cvt_pk_bf16_f32 v100, v22, v23
    v_lshlrev_b32 v24, 16, v101
    v_and_b32 v25, s36, v101
    v_pk_mul_f32 v[24:25], v[24:25], s[34:35] op_sel:[0,1] op_sel_hi:[1,1]
    v_cvt_pk_bf16_f32 v101, v24, v25
    ds_write_b64 v6, v[100:101] offset:5440
    v_lshlrev_b32 v22, 16, v102
    v_and_b32 v23, s36, v102
    v_pk_mul_f32 v[22:23], v[22:23], s[34:35] op_sel:[0,1] op_sel_hi:[1,1]
    v_cvt_pk_bf16_f32 v102, v22, v23
    v_lshlrev_b32 v24, 16, v103
    v_and_b32 v25, s36, v103
    v_pk_mul_f32 v[24:25], v[24:25], s[34:35] op_sel:[0,1] op_sel_hi:[1,1]
    v_cvt_pk_bf16_f32 v103, v24, v25
    ds_write_b64 v6, v[102:103] offset:5448
    s_waitcnt vmcnt(13)
    v_lshlrev_b32 v22, 16, v104
    buffer_load_dwordx4 v94, s[12:15], s58 offen offset:2048 nt lds
    v_and_b32 v23, s36, v104
    v_pk_mul_f32 v[22:23], v[22:23], s[34:35] op_sel:[0,1] op_sel_hi:[1,1]
    v_cvt_pk_bf16_f32 v104, v22, v23
    v_lshlrev_b32 v24, 16, v105
    v_and_b32 v25, s36, v105
    v_pk_mul_f32 v[24:25], v[24:25], s[34:35] op_sel:[0,1] op_sel_hi:[1,1]
    v_cvt_pk_bf16_f32 v105, v24, v25
    ds_write_b64 v6, v[104:105] offset:6528
    v_lshlrev_b32 v22, 16, v106
    v_and_b32 v23, s36, v106
    v_pk_mul_f32 v[22:23], v[22:23], s[34:35] op_sel:[0,1] op_sel_hi:[1,1]
    v_cvt_pk_bf16_f32 v106, v22, v23
    v_lshlrev_b32 v24, 16, v107
    v_and_b32 v25, s36, v107
    v_pk_mul_f32 v[24:25], v[24:25], s[34:35] op_sel:[0,1] op_sel_hi:[1,1]
    v_cvt_pk_bf16_f32 v107, v24, v25
    ds_write_b64 v6, v[106:107] offset:6536
    s_waitcnt vmcnt(13)
    v_lshlrev_b32 v22, 16, v108
    buffer_load_dwordx4 v95, s[12:15], s58 offen offset:3072 nt lds
    v_and_b32 v23, s36, v108
    v_pk_mul_f32 v[22:23], v[22:23], s[34:35] op_sel:[0,1] op_sel_hi:[1,1]
    v_cvt_pk_bf16_f32 v108, v22, v23
    v_lshlrev_b32 v24, 16, v109
    v_and_b32 v25, s36, v109
    v_pk_mul_f32 v[24:25], v[24:25], s[34:35] op_sel:[0,1] op_sel_hi:[1,1]
    v_cvt_pk_bf16_f32 v109, v24, v25
    ds_write_b64 v6, v[108:109] offset:7616
    v_lshlrev_b32 v22, 16, v110
    v_and_b32 v23, s36, v110
    v_pk_mul_f32 v[22:23], v[22:23], s[34:35] op_sel:[0,1] op_sel_hi:[1,1]
    v_cvt_pk_bf16_f32 v110, v22, v23
    v_lshlrev_b32 v24, 16, v111
    v_and_b32 v25, s36, v111
    v_pk_mul_f32 v[24:25], v[24:25], s[34:35] op_sel:[0,1] op_sel_hi:[1,1]
    v_cvt_pk_bf16_f32 v111, v24, v25
    ds_write_b64 v6, v[110:111] offset:7624
    ds_read_b128 a[48:51], v7 offset:4352
    ds_read_b128 a[52:55], v7 offset:4416
    ds_read_b128 a[56:59], v7 offset:4480
    ds_read_b128 a[60:63], v7 offset:4544
    s_waitcnt lgkmcnt(15)
    v_mfma_f32_16x16x32_bf16 v[36:39], a[128:131], a[32:35], 0
    s_waitcnt lgkmcnt(14)
    v_mfma_f32_16x16x32_bf16 v[36:39], a[132:135], a[36:39], v[36:39]
    s_waitcnt lgkmcnt(13)
    v_mfma_f32_16x16x32_bf16 v[36:39], a[136:139], a[40:43], v[36:39]
    s_waitcnt lgkmcnt(12)
    v_mfma_f32_16x16x32_bf16 v[36:39], a[140:143], a[44:47], v[36:39]
    v_mfma_f32_16x16x32_bf16 v[40:43], a[144:147], a[32:35], 0
    v_mfma_f32_16x16x32_bf16 v[40:43], a[148:151], a[36:39], v[40:43]
    v_mfma_f32_16x16x32_bf16 v[40:43], a[152:155], a[40:43], v[40:43]
    v_mfma_f32_16x16x32_bf16 v[40:43], a[156:159], a[44:47], v[40:43]
    s_waitcnt vmcnt(10)
    s_barrier
    s_waitcnt lgkmcnt(3)
    v_mfma_f32_16x16x32_bf16 v[44:47], a[128:131], a[48:51], 0
    ds_read_b128 a[128:131], v9 offset:8192
    s_add_u32 m0, s39, 0
    s_waitcnt lgkmcnt(3)
    v_mfma_f32_16x16x32_bf16 v[44:47], a[132:135], a[52:55], v[44:47]
    ds_read_b128 a[132:135], v10 offset:8192
    buffer_load_dwordx4 v92, s[12:15], s59 offen offset:0 nt lds
    s_waitcnt lgkmcnt(3)
    v_mfma_f32_16x16x32_bf16 v[44:47], a[136:139], a[56:59], v[44:47]
    ds_read_b128 a[136:139], v11 offset:8192
    buffer_load_dwordx4 v93, s[12:15], s59 offen offset:1024 nt lds
    s_waitcnt lgkmcnt(3)
    v_mfma_f32_16x16x32_bf16 v[44:47], a[140:143], a[60:63], v[44:47]
    ds_read_b128 a[140:143], v12 offset:8192
    buffer_load_dwordx4 v94, s[12:15], s59 offen offset:2048 nt lds
    v_mfma_f32_16x16x32_bf16 v[48:51], a[144:147], a[48:51], 0
    ds_read_b128 a[144:147], v9 offset:12288
    buffer_load_dwordx4 v95, s[12:15], s59 offen offset:3072 nt lds
    v_mfma_f32_16x16x32_bf16 v[48:51], a[148:151], a[52:55], v[48:51]
    ds_read_b128 a[148:151], v10 offset:12288
    s_add_u32 m0, s34, 16384
    v_mfma_f32_16x16x32_bf16 v[48:51], a[152:155], a[56:59], v[48:51]
    ds_read_b128 a[152:155], v11 offset:12288
    v_max3_f32 v22, v36, v37, v38
    v_mfma_f32_16x16x32_bf16 v[48:51], a[156:159], a[60:63], v[48:51]
    ds_read_b128 a[156:159], v12 offset:12288
    s_waitcnt lgkmcnt(4)
    v_mfma_f32_16x16x32_bf16 v[52:55], a[128:131], a[32:35], 0
    v_max3_f32 v23, v39, v40, v41
    v_max3_f32 v22, v22, v42, v43
    v_mfma_f32_16x16x32_bf16 v[52:55], a[132:135], a[36:39], v[52:55]
    v_max_f32 v22, v22, v23
    v_mov_b32 v23, v22
    v_mfma_f32_16x16x32_bf16 v[52:55], a[136:139], a[40:43], v[52:55]
    v_mfma_f32_16x16x32_bf16 v[52:55], a[140:143], a[44:47], v[52:55]
    s_waitcnt lgkmcnt(0)
    v_permlane32_swap_b32 v22, v23
    v_mfma_f32_16x16x32_bf16 v[56:59], a[144:147], a[32:35], 0
    v_max_f32 v22, v22, v23
    v_mov_b32 v23, v22
    v_mfma_f32_16x16x32_bf16 v[56:59], a[148:151], a[36:39], v[56:59]
    v_mfma_f32_16x16x32_bf16 v[56:59], a[152:155], a[40:43], v[56:59]
    s_barrier
    v_permlane16_swap_b32 v22, v23
    v_mfma_f32_16x16x32_bf16 v[56:59], a[156:159], a[44:47], v[56:59]
    ds_read_b64_tr_b16 a[160:161], v13 offset:0
    ds_read_b64_tr_b16 a[162:163], v13 offset:4096
    s_waitcnt vmcnt(10)
    s_barrier
    v_mfma_f32_16x16x32_bf16 v[60:63], a[128:131], a[48:51], 0
    ds_read_b128 a[128:131], v9 offset:16384
    ds_read_b64_tr_b16 a[164:165], v14 offset:0
    ds_read_b64_tr_b16 a[166:167], v14 offset:4096
    v_mfma_f32_16x16x32_bf16 v[60:63], a[132:135], a[52:55], v[60:63]
    ds_read_b64_tr_b16 a[168:169], v15 offset:0
    ds_read_b64_tr_b16 a[170:171], v15 offset:4096
    v_mfma_f32_16x16x32_bf16 v[60:63], a[136:139], a[56:59], v[60:63]
    ds_read_b128 a[132:135], v10 offset:16384
    ds_read_b64_tr_b16 a[172:173], v16 offset:0
    ds_read_b64_tr_b16 a[174:175], v16 offset:4096
    v_mfma_f32_16x16x32_bf16 v[60:63], a[140:143], a[60:63], v[60:63]
    ds_read_b64_tr_b16 a[176:177], v17 offset:0
    ds_read_b64_tr_b16 a[178:179], v17 offset:4096
    v_mfma_f32_16x16x32_bf16 v[64:67], a[144:147], a[48:51], 0
    ds_read_b64_tr_b16 a[180:181], v18 offset:0
    ds_read_b64_tr_b16 a[182:183], v18 offset:4096
    v_mfma_f32_16x16x32_bf16 v[64:67], a[148:151], a[52:55], v[64:67]
    ds_read_b128 a[136:139], v11 offset:16384
    ds_read_b64_tr_b16 a[184:185], v19 offset:0
    ds_read_b64_tr_b16 a[186:187], v19 offset:4096
    v_mfma_f32_16x16x32_bf16 v[64:67], a[152:155], a[56:59], v[64:67]
    ds_read_b64_tr_b16 a[188:189], v20 offset:0
    ds_read_b64_tr_b16 a[190:191], v20 offset:4096
    v_mfma_f32_16x16x32_bf16 v[64:67], a[156:159], a[60:63], v[64:67]
    buffer_load_dwordx4 v4, s[20:23], s42 offen offset:0 nt lds
    v_max_f32 v22, v22, v23
    v_sub_f32 v68, 0, v22
    v_add_f32 v36, v68, v36
    v_add_f32 v37, v68, v37
    v_add_f32 v38, v68, v38
    v_add_f32 v39, v68, v39
    v_exp_f32 v36, v36
    v_exp_f32 v37, v37
    v_add_f32 v40, v68, v40
    v_add_f32 v41, v68, v41
    v_cvt_pk_bf16_f32 v36, v36, v37
    v_exp_f32 v38, v38
    v_exp_f32 v39, v39
    v_add_f32 v42, v68, v42
    v_add_f32 v43, v68, v43
    v_cvt_pk_bf16_f32 v37, v38, v39
    v_exp_f32 v40, v40
    v_exp_f32 v41, v41
    v_exp_f32 v42, v42
    v_cvt_pk_bf16_f32 v38, v40, v41
    v_exp_f32 v43, v43
    v_max3_f32 v22, v44, v45, v46
    v_cvt_pk_bf16_f32 v39, v42, v43
    v_max3_f32 v23, v47, v48, v49
    v_max3_f32 v22, v22, v50, v51
    v_mfma_f32_16x16x32_bf16 a[192:195], a[216:219], v[36:39], 0
    ds_read_b128 a[140:143], v12 offset:16384
    buffer_load_dwordx4 v5, s[20:23], s42 offen offset:1024 nt lds
    v_max_f32 v22, v22, v23
    v_mov_b32 v23, v22
    v_mov_b32 v69, v68
    v_mov_b32 v70, v68
    v_permlane32_swap_b32 v22, v23
    v_max_f32 v22, v22, v23
    v_mov_b32 v23, v22
    v_mov_b32 v71, v68
    v_add_f32 v52, v68, v52
    v_permlane16_swap_b32 v22, v23
    v_max_f32 v22, v22, v23
    v_sub_f32 v72, 0, v22
    v_add_f32 v44, v72, v44
    v_add_f32 v45, v72, v45
    v_add_f32 v46, v72, v46
    v_add_f32 v47, v72, v47
    v_exp_f32 v44, v44
    v_exp_f32 v45, v45
    v_add_f32 v48, v72, v48
    v_add_f32 v49, v72, v49
    v_cvt_pk_bf16_f32 v44, v44, v45
    v_exp_f32 v46, v46
    v_exp_f32 v47, v47
    v_add_f32 v50, v72, v50
    v_add_f32 v51, v72, v51
    v_cvt_pk_bf16_f32 v45, v46, v47
    v_exp_f32 v48, v48
    v_exp_f32 v49, v49
    v_exp_f32 v50, v50
    v_cvt_pk_bf16_f32 v46, v48, v49
    v_exp_f32 v51, v51
    v_mov_b32 v73, v72
    v_cvt_pk_bf16_f32 v47, v50, v51
    v_mov_b32 v74, v72
    v_mov_b32 v75, v72
    v_mfma_f32_16x16x32_bf16 a[196:199], a[216:219], v[44:47], 0
    s_waitcnt lgkmcnt(1)
    s_add_u32 m0, s33, 24576
    v_mfma_f32_16x16x32_bf16 a[0:3], a[160:163], v[36:39], 0
    ds_read_b128 a[144:147], v9 offset:20480
    buffer_load_dwordx4 v2, s[16:19], s43 offen offset:0 nt lds
    s_waitcnt vmcnt(11)
    s_barrier
    v_mfma_f32_16x16x32_bf16 v[96:99], a[160:163], v[44:47], 0
    ds_read_b64_tr_b16 a[160:161], v13 offset:8192
    buffer_load_dwordx4 v3, s[16:19], s43 offen offset:1024 nt lds
    v_mfma_f32_16x16x32_bf16 v[100:103], a[164:167], v[44:47], 0
    ds_read_b64_tr_b16 a[162:163], v13 offset:12288
    s_add_u32 m0, s34, 24576
    v_mfma_f32_16x16x32_bf16 a[4:7], a[164:167], v[36:39], 0
    ds_read_b128 a[148:151], v10 offset:20480
    buffer_load_dwordx4 v4, s[20:23], s43 offen offset:0 nt lds
    v_mfma_f32_16x16x32_bf16 a[8:11], a[168:171], v[36:39], 0
    ds_read_b64_tr_b16 a[164:165], v14 offset:8192
    buffer_load_dwordx4 v5, s[20:23], s43 offen offset:1024 nt lds
    v_mfma_f32_16x16x32_bf16 v[104:107], a[168:171], v[44:47], 0
    s_add_u32 m0, s33, 32768
    v_add_f32 v53, v68, v53
    v_mfma_f32_16x16x32_bf16 v[108:111], a[172:175], v[44:47], 0
    ds_read_b64_tr_b16 a[166:167], v14 offset:12288
    ds_read_b128 a[152:155], v11 offset:20480
    v_mfma_f32_16x16x32_bf16 a[12:15], a[172:175], v[36:39], 0
    v_exp_f32 v52, v52
    v_mfma_f32_16x16x32_bf16 a[16:19], a[176:179], v[36:39], 0
    ds_read_b64_tr_b16 a[168:169], v15 offset:8192
    v_add_f32 v54, v68, v54
    v_mfma_f32_16x16x32_bf16 v[112:115], a[176:179], v[44:47], 0
    ds_read_b128 a[156:159], v12 offset:20480
    v_add_f32 v55, v68, v55
    v_mfma_f32_16x16x32_bf16 v[116:119], a[180:183], v[44:47], 0
    ds_read_b64_tr_b16 a[170:171], v15 offset:12288
    v_add_f32 v56, v68, v56
    v_mfma_f32_16x16x32_bf16 a[20:23], a[180:183], v[36:39], 0
    ds_read_b64_tr_b16 a[172:173], v16 offset:8192
    v_add_f32 v57, v68, v57
    v_mfma_f32_16x16x32_bf16 a[24:27], a[184:187], v[36:39], 0
    v_exp_f32 v53, v53
    v_mfma_f32_16x16x32_bf16 v[120:123], a[184:187], v[44:47], 0
    ds_read_b64_tr_b16 a[174:175], v16 offset:12288
    v_cvt_pk_bf16_f32 v52, v52, v53
    v_mfma_f32_16x16x32_bf16 v[124:127], a[188:191], v[44:47], 0
    v_exp_f32 v54, v54
    v_mfma_f32_16x16x32_bf16 a[28:31], a[188:191], v[36:39], 0
    ds_read_b64_tr_b16 a[176:177], v17 offset:8192
    s_waitcnt lgkmcnt(4)
    v_mfma_f32_16x16x32_bf16 v[36:39], a[128:131], a[32:35], v[68:71]
    v_exp_f32 v55, v55
    v_mfma_f32_16x16x32_bf16 v[36:39], a[132:135], a[36:39], v[36:39]
    ds_read_b64_tr_b16 a[178:179], v17 offset:12288
    v_add_f32 v58, v68, v58
    v_mfma_f32_16x16x32_bf16 v[36:39], a[136:139], a[40:43], v[36:39]
    v_exp_f32 v56, v56
    v_mfma_f32_16x16x32_bf16 v[36:39], a[140:143], a[44:47], v[36:39]
    ds_read_b64_tr_b16 a[180:181], v18 offset:8192
    v_add_f32 v59, v68, v59
    v_mfma_f32_16x16x32_bf16 v[40:43], a[144:147], a[32:35], v[68:71]
    ds_read_b64_tr_b16 a[182:183], v18 offset:12288
    v_cvt_pk_bf16_f32 v53, v54, v55
    v_mfma_f32_16x16x32_bf16 v[40:43], a[148:151], a[36:39], v[40:43]
    v_exp_f32 v57, v57
    v_mfma_f32_16x16x32_bf16 v[40:43], a[152:155], a[40:43], v[40:43]
    ds_read_b64_tr_b16 a[184:185], v19 offset:8192
    v_cvt_pk_bf16_f32 v54, v56, v57
    v_mfma_f32_16x16x32_bf16 v[40:43], a[156:159], a[44:47], v[40:43]
    v_exp_f32 v58, v58
    v_mfma_f32_16x16x32_bf16 v[44:47], a[128:131], a[48:51], v[72:75]
    ds_read_b64_tr_b16 a[186:187], v19 offset:12288
    v_add_f32 v60, v72, v60
    v_mfma_f32_16x16x32_bf16 v[44:47], a[132:135], a[52:55], v[44:47]
    v_exp_f32 v59, v59
    v_mfma_f32_16x16x32_bf16 v[44:47], a[136:139], a[56:59], v[44:47]
    ds_read_b64_tr_b16 a[188:189], v20 offset:8192
    v_cvt_pk_bf16_f32 v55, v58, v59
    v_mfma_f32_16x16x32_bf16 v[44:47], a[140:143], a[60:63], v[44:47]
    v_exp_f32 v60, v60
    v_mfma_f32_16x16x32_bf16 v[48:51], a[144:147], a[48:51], v[72:75]
    ds_read_b64_tr_b16 a[190:191], v20 offset:12288
    v_add_f32 v61, v72, v61
    v_mfma_f32_16x16x32_bf16 v[48:51], a[148:151], a[52:55], v[48:51]
    v_exp_f32 v61, v61
    v_mfma_f32_16x16x32_bf16 v[48:51], a[152:155], a[56:59], v[48:51]
    v_add_f32 v62, v72, v62
    v_add_f32 v63, v72, v63
    v_mfma_f32_16x16x32_bf16 v[48:51], a[156:159], a[60:63], v[48:51]
    v_add_f32 v64, v72, v64
    v_add_f32 v65, v72, v65
    v_mfma_f32_16x16x32_bf16 a[192:195], a[216:219], v[52:55], a[192:195]
    v_cvt_pk_bf16_f32 v60, v60, v61
    v_add_f32 v66, v72, v66
    v_exp_f32 v62, v62
    v_exp_f32 v63, v63
    v_add_f32 v67, v72, v67
    v_cvt_pk_bf16_f32 v61, v62, v63
    v_exp_f32 v64, v64
    v_exp_f32 v65, v65
    v_exp_f32 v66, v66
    v_cvt_pk_bf16_f32 v62, v64, v65
    v_exp_f32 v67, v67
    s_nop 0
    v_cvt_pk_bf16_f32 v63, v66, v67
    s_nop 1
    v_mfma_f32_16x16x32_bf16 a[196:199], a[216:219], v[60:63], a[196:199]
    s_waitcnt lgkmcnt(0)
    v_mfma_f32_16x16x32_bf16 a[0:3], a[160:163], v[52:55], a[0:3]
    s_waitcnt vmcnt(4)
    s_barrier
    v_mfma_f32_16x16x32_bf16 v[96:99], a[160:163], v[60:63], v[96:99]
    ds_read_b64_tr_b16 a[160:161], v13 offset:16384
    buffer_load_dwordx4 v2, s[16:19], s44 offen offset:0 nt lds
    v_mfma_f32_16x16x32_bf16 v[100:103], a[164:167], v[60:63], v[100:103]
    ds_read_b64_tr_b16 a[162:163], v13 offset:20480
    v_mfma_f32_16x16x32_bf16 a[4:7], a[164:167], v[52:55], a[4:7]
    v_exp_f32 v36, v36
    v_mfma_f32_16x16x32_bf16 a[8:11], a[168:171], v[52:55], a[8:11]
    ds_read_b64_tr_b16 a[164:165], v14 offset:16384
    v_mfma_f32_16x16x32_bf16 v[104:107], a[168:171], v[60:63], v[104:107]
    buffer_load_dwordx4 v3, s[16:19], s44 offen offset:1024 nt lds
    s_add_u32 m0, s34, 32768
    v_mfma_f32_16x16x32_bf16 v[108:111], a[172:175], v[60:63], v[108:111]
    ds_read_b64_tr_b16 a[166:167], v14 offset:20480
    v_mfma_f32_16x16x32_bf16 a[12:15], a[172:175], v[52:55], a[12:15]
    ds_read_b128 a[64:67], v0 offset:8704
    ds_read_b128 a[68:71], v21 offset:8704
    v_mfma_f32_16x16x32_bf16 a[16:19], a[176:179], v[52:55], a[16:19]
    ds_read_b64_tr_b16 a[168:169], v15 offset:16384
    ds_read_b128 a[72:75], v26 offset:8704
    v_mfma_f32_16x16x32_bf16 v[112:115], a[176:179], v[60:63], v[112:115]
    buffer_load_dwordx4 v4, s[20:23], s44 offen offset:0 nt lds
    ds_read_b128 a[76:79], v27 offset:8704
    v_mfma_f32_16x16x32_bf16 v[116:119], a[180:183], v[60:63], v[116:119]
    ds_read_b64_tr_b16 a[170:171], v15 offset:20480
    v_mfma_f32_16x16x32_bf16 a[20:23], a[180:183], v[52:55], a[20:23]
    ds_read_b64_tr_b16 a[172:173], v16 offset:16384
    v_mfma_f32_16x16x32_bf16 a[24:27], a[184:187], v[52:55], a[24:27]
    v_exp_f32 v37, v37
    v_mfma_f32_16x16x32_bf16 v[120:123], a[184:187], v[60:63], v[120:123]
    ds_read_b64_tr_b16 a[174:175], v16 offset:20480
    buffer_load_dwordx4 v5, s[20:23], s44 offen offset:1024 nt lds
    v_mfma_f32_16x16x32_bf16 v[124:127], a[188:191], v[60:63], v[124:127]
    s_add_u32 m0, s39, 4352
    v_cvt_pk_bf16_f32 v36, v36, v37
    v_mfma_f32_16x16x32_bf16 a[28:31], a[188:191], v[52:55], a[28:31]
    ds_read_b64_tr_b16 a[176:177], v17 offset:16384
    ds_read_b128 a[80:83], v0 offset:0
    s_waitcnt lgkmcnt(9)
    v_mfma_f32_16x16x32_bf16 v[52:55], a[128:131], a[64:67], 0
    ds_read_b128 a[84:87], v21 offset:0
    ds_read_b128 a[88:91], v26 offset:0
    s_waitcnt lgkmcnt(10)
    v_mfma_f32_16x16x32_bf16 v[52:55], a[132:135], a[68:71], v[52:55]
    ds_read_b64_tr_b16 a[178:179], v17 offset:20480
    buffer_load_dwordx4 v92, s[12:15], s60 offen offset:0 nt lds
    s_waitcnt lgkmcnt(9)
    v_mfma_f32_16x16x32_bf16 v[52:55], a[136:139], a[72:75], v[52:55]
    ds_read_b128 a[92:95], v27 offset:0
    s_waitcnt lgkmcnt(9)
    v_mfma_f32_16x16x32_bf16 v[52:55], a[140:143], a[76:79], v[52:55]
    ds_read_b64_tr_b16 a[180:181], v18 offset:16384
    v_mfma_f32_16x16x32_bf16 v[56:59], a[144:147], a[64:67], 0
    ds_read_b64_tr_b16 a[182:183], v18 offset:20480
    v_mfma_f32_16x16x32_bf16 v[56:59], a[148:151], a[68:71], v[56:59]
    buffer_load_dwordx4 v93, s[12:15], s60 offen offset:1024 nt lds
    v_mfma_f32_16x16x32_bf16 v[56:59], a[152:155], a[72:75], v[56:59]
    ds_read_b64_tr_b16 a[184:185], v19 offset:16384
    v_mfma_f32_16x16x32_bf16 v[56:59], a[156:159], a[76:79], v[56:59]
    s_waitcnt vmcnt(8)
    s_barrier
    s_waitcnt lgkmcnt(7)
    v_mfma_f32_16x16x32_bf16 v[60:63], a[128:131], a[80:83], 0
    ds_read_b64_tr_b16 a[186:187], v19 offset:20480
    ds_read_b128 a[128:131], v9 offset:24576
    s_waitcnt lgkmcnt(8)
    v_mfma_f32_16x16x32_bf16 v[60:63], a[132:135], a[84:87], v[60:63]
    buffer_load_dwordx4 v94, s[12:15], s60 offen offset:2048 nt lds
    v_max3_f32 v22, v52, v53, v54
    s_waitcnt lgkmcnt(7)
    v_mfma_f32_16x16x32_bf16 v[60:63], a[136:139], a[88:91], v[60:63]
    ds_read_b64_tr_b16 a[188:189], v20 offset:16384
    ds_read_b128 a[132:135], v10 offset:24576
    s_waitcnt lgkmcnt(7)
    v_mfma_f32_16x16x32_bf16 v[60:63], a[140:143], a[92:95], v[60:63]
    v_exp_f32 v38, v38
    v_mfma_f32_16x16x32_bf16 v[64:67], a[144:147], a[80:83], 0
    ds_read_b64_tr_b16 a[190:191], v20 offset:20480
    v_max3_f32 v23, v55, v56, v57
    v_mfma_f32_16x16x32_bf16 v[64:67], a[148:151], a[84:87], v[64:67]
    ds_read_b128 a[136:139], v11 offset:24576
    buffer_load_dwordx4 v95, s[12:15], s60 offen offset:3072 nt lds
    v_mfma_f32_16x16x32_bf16 v[64:67], a[152:155], a[88:91], v[64:67]
    s_add_u32 m0, s39, 8704
    v_max3_f32 v22, v22, v58, v59
    v_mfma_f32_16x16x32_bf16 v[64:67], a[156:159], a[92:95], v[64:67]
    v_exp_f32 v39, v39
    v_exp_f32 v40, v40
    v_cvt_pk_bf16_f32 v37, v38, v39
    v_exp_f32 v41, v41
    v_exp_f32 v42, v42
    v_cvt_pk_bf16_f32 v38, v40, v41
    v_exp_f32 v43, v43
    v_max_f32 v22, v22, v23
    v_cvt_pk_bf16_f32 v39, v42, v43
    v_mov_b32 v23, v22
    s_nop 0
    v_mfma_f32_16x16x32_bf16 a[192:195], a[216:219], v[36:39], a[192:195]
    ds_read_b128 a[140:143], v12 offset:24576
    v_permlane32_swap_b32 v22, v23
    v_exp_f32 v44, v44
    v_exp_f32 v45, v45
    v_exp_f32 v46, v46
    v_cvt_pk_bf16_f32 v44, v44, v45
    v_exp_f32 v47, v47
    v_exp_f32 v48, v48
    v_cvt_pk_bf16_f32 v45, v46, v47
    v_exp_f32 v49, v49
    v_exp_f32 v50, v50
    v_cvt_pk_bf16_f32 v46, v48, v49
    v_exp_f32 v51, v51
    v_max_f32 v22, v22, v23
    v_cvt_pk_bf16_f32 v47, v50, v51
    v_mov_b32 v23, v22
    s_nop 0
    v_mfma_f32_16x16x32_bf16 a[196:199], a[216:219], v[44:47], a[196:199]
    buffer_load_dwordx4 v92, s[12:15], s61 offen offset:0 nt lds
    s_waitcnt lgkmcnt(2)
    v_mfma_f32_16x16x32_bf16 a[0:3], a[160:163], v[36:39], a[0:3]
    ds_read_b128 a[144:147], v9 offset:28672
    v_permlane16_swap_b32 v22, v23
    v_mfma_f32_16x16x32_bf16 v[96:99], a[160:163], v[44:47], v[96:99]
    v_max_f32 v22, v22, v23
    v_mul_f32 v76, s37, v22
    v_mfma_f32_16x16x32_bf16 v[100:103], a[164:167], v[44:47], v[100:103]
    v_fma_f32 v52, v52, s35, v76
    v_fma_f32 v53, v53, s35, v76
    v_mfma_f32_16x16x32_bf16 a[4:7], a[164:167], v[36:39], a[4:7]
    ds_read_b128 a[148:151], v10 offset:28672
    buffer_load_dwordx4 v93, s[12:15], s61 offen offset:1024 nt lds
    v_mfma_f32_16x16x32_bf16 a[8:11], a[168:171], v[36:39], a[8:11]
    v_exp_f32 v52, v52
    v_mfma_f32_16x16x32_bf16 v[104:107], a[168:171], v[44:47], v[104:107]
    v_exp_f32 v53, v53
    v_mfma_f32_16x16x32_bf16 v[108:111], a[172:175], v[44:47], v[108:111]
    ds_read_b128 a[152:155], v11 offset:28672
    v_fma_f32 v54, v54, s35, v76
    v_mfma_f32_16x16x32_bf16 a[12:15], a[172:175], v[36:39], a[12:15]
    buffer_load_dwordx4 v94, s[12:15], s61 offen offset:2048 nt lds
    v_fma_f32 v55, v55, s35, v76
    v_mfma_f32_16x16x32_bf16 a[16:19], a[176:179], v[36:39], a[16:19]
    v_exp_f32 v54, v54
    v_mfma_f32_16x16x32_bf16 v[112:115], a[176:179], v[44:47], v[112:115]
    ds_read_b128 a[156:159], v12 offset:28672
    v_fma_f32 v56, v56, s35, v76
    v_mfma_f32_16x16x32_bf16 v[116:119], a[180:183], v[44:47], v[116:119]
    v_exp_f32 v55, v55
    v_mfma_f32_16x16x32_bf16 a[20:23], a[180:183], v[36:39], a[20:23]
    buffer_load_dwordx4 v95, s[12:15], s61 offen offset:3072 nt lds
    s_add_u32 m0, s33, 40960
    v_mfma_f32_16x16x32_bf16 a[24:27], a[184:187], v[36:39], a[24:27]
    v_exp_f32 v56, v56
    v_mfma_f32_16x16x32_bf16 v[120:123], a[184:187], v[44:47], v[120:123]
    v_fma_f32 v57, v57, s35, v76
    v_cvt_pk_bf16_f32 v52, v52, v53
    v_mfma_f32_16x16x32_bf16 v[124:127], a[188:191], v[44:47], v[124:127]
    v_exp_f32 v57, v57
    v_mfma_f32_16x16x32_bf16 a[28:31], a[188:191], v[36:39], a[28:31]
    s_waitcnt lgkmcnt(0)
    v_fma_f32 v58, v58, s35, v76
    v_mfma_f32_16x16x32_bf16 v[36:39], a[128:131], a[32:35], v[68:71]
    v_exp_f32 v58, v58
    v_mfma_f32_16x16x32_bf16 v[36:39], a[132:135], a[36:39], v[36:39]
    v_fma_f32 v59, v59, s35, v76
    v_cvt_pk_bf16_f32 v53, v54, v55
    v_mfma_f32_16x16x32_bf16 v[36:39], a[136:139], a[40:43], v[36:39]
    v_exp_f32 v59, v59
    v_mfma_f32_16x16x32_bf16 v[36:39], a[140:143], a[44:47], v[36:39]
    v_cvt_pk_bf16_f32 v54, v56, v57
    v_cvt_pk_bf16_f32 v55, v58, v59
    v_mfma_f32_16x16x32_bf16 v[40:43], a[144:147], a[32:35], v[68:71]
    v_max3_f32 v22, v60, v61, v62
    v_max3_f32 v23, v63, v64, v65
    v_mfma_f32_16x16x32_bf16 v[40:43], a[148:151], a[36:39], v[40:43]
    v_max3_f32 v22, v22, v66, v67
    v_max_f32 v22, v22, v23
    v_mfma_f32_16x16x32_bf16 v[40:43], a[152:155], a[40:43], v[40:43]
    v_mov_b32 v23, v22
    v_mfma_f32_16x16x32_bf16 v[40:43], a[156:159], a[44:47], v[40:43]
    v_exp_f32 v36, v36
    v_mfma_f32_16x16x32_bf16 v[44:47], a[128:131], a[48:51], v[72:75]
    v_permlane32_swap_b32 v22, v23
    v_max_f32 v22, v22, v23
    v_mfma_f32_16x16x32_bf16 v[44:47], a[132:135], a[52:55], v[44:47]
    v_mov_b32 v23, v22
    v_mfma_f32_16x16x32_bf16 v[44:47], a[136:139], a[56:59], v[44:47]
    v_exp_f32 v37, v37
    v_mfma_f32_16x16x32_bf16 v[44:47], a[140:143], a[60:63], v[44:47]
    v_permlane16_swap_b32 v22, v23
    v_max_f32 v22, v22, v23
    v_mfma_f32_16x16x32_bf16 v[48:51], a[144:147], a[48:51], v[72:75]
    v_mul_f32 v80, s37, v22
    v_fma_f32 v60, v60, s35, v80
    v_mfma_f32_16x16x32_bf16 v[48:51], a[148:151], a[52:55], v[48:51]
    v_exp_f32 v60, v60
    v_mfma_f32_16x16x32_bf16 v[48:51], a[152:155], a[56:59], v[48:51]
    v_fma_f32 v61, v61, s35, v80
    v_fma_f32 v62, v62, s35, v80
    v_mfma_f32_16x16x32_bf16 v[48:51], a[156:159], a[60:63], v[48:51]
    v_fma_f32 v63, v63, s35, v80
    v_fma_f32 v64, v64, s35, v80
    v_mfma_f32_16x16x32_bf16 a[200:203], a[216:219], v[52:55], 0
    v_exp_f32 v61, v61
    v_fma_f32 v65, v65, s35, v80
    v_cvt_pk_bf16_f32 v60, v60, v61
    v_exp_f32 v62, v62
    v_exp_f32 v63, v63
    v_fma_f32 v66, v66, s35, v80
    v_fma_f32 v67, v67, s35, v80
    v_cvt_pk_bf16_f32 v61, v62, v63
    v_exp_f32 v64, v64
    v_exp_f32 v65, v65
    v_exp_f32 v66, v66
    v_cvt_pk_bf16_f32 v62, v64, v65
    v_exp_f32 v67, v67
    v_cvt_pk_bf16_f32 v36, v36, v37
    v_cvt_pk_bf16_f32 v63, v66, v67
    s_nop 1
    v_mfma_f32_16x16x32_bf16 a[204:207], a[216:219], v[60:63], 0
    v_exp_f32 v38, v38
    v_mfma_f32_16x16x32_bf16 v[128:131], a[160:163], v[52:55], 0
    s_waitcnt vmcnt(12)
    s_barrier
    v_mfma_f32_16x16x32_bf16 v[160:163], a[160:163], v[60:63], 0
    ds_read_b64_tr_b16 a[160:161], v13 offset:24576
    buffer_load_dwordx4 v2, s[16:19], s45 offen offset:0 nt lds
    v_mfma_f32_16x16x32_bf16 v[164:167], a[164:167], v[60:63], 0
    ds_read_b64_tr_b16 a[162:163], v13 offset:28672
    v_mfma_f32_16x16x32_bf16 v[132:135], a[164:167], v[52:55], 0
    v_exp_f32 v39, v39
    v_mfma_f32_16x16x32_bf16 v[136:139], a[168:171], v[52:55], 0
    ds_read_b64_tr_b16 a[164:165], v14 offset:24576
    v_cvt_pk_bf16_f32 v37, v38, v39
    v_mfma_f32_16x16x32_bf16 v[168:171], a[168:171], v[60:63], 0
    buffer_load_dwordx4 v3, s[16:19], s45 offen offset:1024 nt lds
    s_add_u32 m0, s34, 40960
    v_mfma_f32_16x16x32_bf16 v[172:175], a[172:175], v[60:63], 0
    ds_read_b64_tr_b16 a[166:167], v14 offset:28672
    v_mfma_f32_16x16x32_bf16 v[140:143], a[172:175], v[52:55], 0
    v_exp_f32 v40, v40
    v_mfma_f32_16x16x32_bf16 v[144:147], a[176:179], v[52:55], 0
    ds_read_b64_tr_b16 a[168:169], v15 offset:24576
    v_mfma_f32_16x16x32_bf16 v[176:179], a[176:179], v[60:63], 0
    v_exp_f32 v41, v41
    v_mfma_f32_16x16x32_bf16 v[180:183], a[180:183], v[60:63], 0
    ds_read_b64_tr_b16 a[170:171], v15 offset:28672
    v_cvt_pk_bf16_f32 v38, v40, v41
    v_mfma_f32_16x16x32_bf16 v[148:151], a[180:183], v[52:55], 0
    ds_read_b64_tr_b16 a[172:173], v16 offset:24576
    v_mfma_f32_16x16x32_bf16 v[152:155], a[184:187], v[52:55], 0
    v_exp_f32 v42, v42
    v_mfma_f32_16x16x32_bf16 v[184:187], a[184:187], v[60:63], 0
    ds_read_b64_tr_b16 a[174:175], v16 offset:28672
    v_mfma_f32_16x16x32_bf16 v[188:191], a[188:191], v[60:63], 0
    v_exp_f32 v43, v43
    v_mfma_f32_16x16x32_bf16 v[156:159], a[188:191], v[52:55], 0
    ds_read_b64_tr_b16 a[176:177], v17 offset:24576
    v_cvt_pk_bf16_f32 v39, v42, v43
    v_mfma_f32_16x16x32_bf16 v[52:55], a[128:131], a[64:67], 0
    v_exp_f32 v44, v44
    v_mfma_f32_16x16x32_bf16 v[52:55], a[132:135], a[68:71], v[52:55]
    ds_read_b64_tr_b16 a[178:179], v17 offset:28672
    v_mfma_f32_16x16x32_bf16 v[52:55], a[136:139], a[72:75], v[52:55]
    v_exp_f32 v45, v45
    v_mfma_f32_16x16x32_bf16 v[52:55], a[140:143], a[76:79], v[52:55]
    ds_read_b64_tr_b16 a[180:181], v18 offset:24576
    v_cvt_pk_bf16_f32 v44, v44, v45
    v_mfma_f32_16x16x32_bf16 v[56:59], a[144:147], a[64:67], 0
    ds_read_b64_tr_b16 a[182:183], v18 offset:28672
    v_mfma_f32_16x16x32_bf16 v[56:59], a[148:151], a[68:71], v[56:59]
    v_exp_f32 v46, v46
    v_mfma_f32_16x16x32_bf16 v[56:59], a[152:155], a[72:75], v[56:59]
    ds_read_b64_tr_b16 a[184:185], v19 offset:24576
    v_fma_f32 v52, v52, s35, v76
    v_mfma_f32_16x16x32_bf16 v[56:59], a[156:159], a[76:79], v[56:59]
    s_waitcnt vmcnt(10)
    s_barrier
    v_mfma_f32_16x16x32_bf16 v[60:63], a[128:131], a[80:83], 0
    ds_read_b64_tr_b16 a[186:187], v19 offset:28672
    ds_read_b128 a[128:131], v9 offset:32768
    v_mfma_f32_16x16x32_bf16 v[60:63], a[132:135], a[84:87], v[60:63]
    buffer_load_dwordx4 v4, s[20:23], s45 offen offset:0 nt lds
    v_fma_f32 v53, v53, s35, v76
    v_mfma_f32_16x16x32_bf16 v[60:63], a[136:139], a[88:91], v[60:63]
    ds_read_b64_tr_b16 a[188:189], v20 offset:24576
    ds_read_b128 a[132:135], v10 offset:32768
    v_mfma_f32_16x16x32_bf16 v[60:63], a[140:143], a[92:95], v[60:63]
    v_exp_f32 v47, v47
    v_mfma_f32_16x16x32_bf16 v[64:67], a[144:147], a[80:83], 0
    ds_read_b64_tr_b16 a[190:191], v20 offset:28672
    v_cvt_pk_bf16_f32 v45, v46, v47
    v_mfma_f32_16x16x32_bf16 v[64:67], a[148:151], a[84:87], v[64:67]
    ds_read_b128 a[136:139], v11 offset:32768
    buffer_load_dwordx4 v5, s[20:23], s45 offen offset:1024 nt lds
    v_mfma_f32_16x16x32_bf16 v[64:67], a[152:155], a[88:91], v[64:67]
    v_exp_f32 v48, v48
    v_mfma_f32_16x16x32_bf16 v[64:67], a[156:159], a[92:95], v[64:67]
    v_exp_f32 v49, v49
    v_mfma_f32_16x16x32_bf16 a[192:195], a[216:219], v[36:39], a[192:195]
    ds_read_b128 a[140:143], v12 offset:32768
    v_cvt_pk_bf16_f32 v46, v48, v49
    v_exp_f32 v50, v50
    v_exp_f32 v51, v51
    v_fma_f32 v54, v54, s35, v76
    v_cvt_pk_bf16_f32 v47, v50, v51
    v_fma_f32 v55, v55, s35, v76
    v_fma_f32 v56, v56, s35, v76
    v_mfma_f32_16x16x32_bf16 a[196:199], a[216:219], v[44:47], a[196:199]
    s_waitcnt lgkmcnt(2)
    v_fma_f32 v57, v57, s35, v76
    v_mfma_f32_16x16x32_bf16 a[0:3], a[160:163], v[36:39], a[0:3]
    ds_read_b128 a[144:147], v9 offset:36864
    v_fma_f32 v58, v58, s35, v76
    v_mfma_f32_16x16x32_bf16 v[96:99], a[160:163], v[44:47], v[96:99]
    v_exp_f32 v52, v52
    v_mfma_f32_16x16x32_bf16 v[100:103], a[164:167], v[44:47], v[100:103]
    v_exp_f32 v53, v53
    v_mfma_f32_16x16x32_bf16 a[4:7], a[164:167], v[36:39], a[4:7]
    ds_read_b128 a[148:151], v10 offset:36864
    v_cvt_pk_bf16_f32 v52, v52, v53
    v_mfma_f32_16x16x32_bf16 a[8:11], a[168:171], v[36:39], a[8:11]
    v_exp_f32 v54, v54
    v_mfma_f32_16x16x32_bf16 v[104:107], a[168:171], v[44:47], v[104:107]
    v_exp_f32 v55, v55
    v_mfma_f32_16x16x32_bf16 v[108:111], a[172:175], v[44:47], v[108:111]
    ds_read_b128 a[152:155], v11 offset:36864
    v_fma_f32 v59, v59, s35, v76
    v_mfma_f32_16x16x32_bf16 a[12:15], a[172:175], v[36:39], a[12:15]
    v_exp_f32 v56, v56
    v_mfma_f32_16x16x32_bf16 a[16:19], a[176:179], v[36:39], a[16:19]
    v_exp_f32 v57, v57
    v_mfma_f32_16x16x32_bf16 v[112:115], a[176:179], v[44:47], v[112:115]
    ds_read_b128 a[156:159], v12 offset:36864
    v_cvt_pk_bf16_f32 v53, v54, v55
    v_mfma_f32_16x16x32_bf16 v[116:119], a[180:183], v[44:47], v[116:119]
    v_exp_f32 v58, v58
    v_mfma_f32_16x16x32_bf16 a[20:23], a[180:183], v[36:39], a[20:23]
    v_exp_f32 v59, v59
    v_mfma_f32_16x16x32_bf16 a[24:27], a[184:187], v[36:39], a[24:27]
    v_cvt_pk_bf16_f32 v54, v56, v57
    v_cvt_pk_bf16_f32 v55, v58, v59
    v_mfma_f32_16x16x32_bf16 v[120:123], a[184:187], v[44:47], v[120:123]
    v_fma_f32 v60, v60, s35, v80
    v_fma_f32 v61, v61, s35, v80
    v_mfma_f32_16x16x32_bf16 v[124:127], a[188:191], v[44:47], v[124:127]
    v_exp_f32 v60, v60
    v_mfma_f32_16x16x32_bf16 a[28:31], a[188:191], v[36:39], a[28:31]
    s_waitcnt lgkmcnt(0)
    v_fma_f32 v62, v62, s35, v80
    v_mfma_f32_16x16x32_bf16 v[36:39], a[128:131], a[32:35], v[68:71]
    v_exp_f32 v61, v61
    v_mfma_f32_16x16x32_bf16 v[36:39], a[132:135], a[36:39], v[36:39]
    v_exp_f32 v62, v62
    v_mfma_f32_16x16x32_bf16 v[36:39], a[136:139], a[40:43], v[36:39]
    v_fma_f32 v63, v63, s35, v80
    v_fma_f32 v64, v64, s35, v80
    v_mfma_f32_16x16x32_bf16 v[36:39], a[140:143], a[44:47], v[36:39]
    v_exp_f32 v63, v63
    v_mfma_f32_16x16x32_bf16 v[40:43], a[144:147], a[32:35], v[68:71]
    v_exp_f32 v64, v64
    v_mfma_f32_16x16x32_bf16 v[40:43], a[148:151], a[36:39], v[40:43]
    v_fma_f32 v65, v65, s35, v80
    v_cvt_pk_bf16_f32 v60, v60, v61
    v_mfma_f32_16x16x32_bf16 v[40:43], a[152:155], a[40:43], v[40:43]
    v_exp_f32 v65, v65
    v_mfma_f32_16x16x32_bf16 v[40:43], a[156:159], a[44:47], v[40:43]
    v_exp_f32 v36, v36
    v_mfma_f32_16x16x32_bf16 v[44:47], a[128:131], a[48:51], v[72:75]
    v_exp_f32 v37, v37
    v_mfma_f32_16x16x32_bf16 v[44:47], a[132:135], a[52:55], v[44:47]
    v_exp_f32 v38, v38
    v_mfma_f32_16x16x32_bf16 v[44:47], a[136:139], a[56:59], v[44:47]
    v_fma_f32 v66, v66, s35, v80
    v_fma_f32 v67, v67, s35, v80
    v_mfma_f32_16x16x32_bf16 v[44:47], a[140:143], a[60:63], v[44:47]
    v_exp_f32 v66, v66
    v_mfma_f32_16x16x32_bf16 v[48:51], a[144:147], a[48:51], v[72:75]
    v_exp_f32 v67, v67
    v_mfma_f32_16x16x32_bf16 v[48:51], a[148:151], a[52:55], v[48:51]
    v_cvt_pk_bf16_f32 v61, v62, v63
    v_cvt_pk_bf16_f32 v62, v64, v65
    v_mfma_f32_16x16x32_bf16 v[48:51], a[152:155], a[56:59], v[48:51]
    v_cvt_pk_bf16_f32 v63, v66, v67
    v_cvt_pk_bf16_f32 v36, v36, v37
    v_mfma_f32_16x16x32_bf16 v[48:51], a[156:159], a[60:63], v[48:51]
    v_exp_f32 v39, v39
    v_mfma_f32_16x16x32_bf16 a[200:203], a[216:219], v[52:55], a[200:203]
    v_exp_f32 v40, v40
    v_mfma_f32_16x16x32_bf16 a[204:207], a[216:219], v[60:63], a[204:207]
    v_exp_f32 v41, v41
    v_mfma_f32_16x16x32_bf16 v[128:131], a[160:163], v[52:55], v[128:131]
    v_exp_f32 v42, v42
    v_mfma_f32_16x16x32_bf16 v[160:163], a[160:163], v[60:63], v[160:163]
    ds_read_b64_tr_b16 a[160:161], v13 offset:32768
    v_cvt_pk_bf16_f32 v37, v38, v39
    v_mfma_f32_16x16x32_bf16 v[164:167], a[164:167], v[60:63], v[164:167]
    ds_read_b64_tr_b16 a[162:163], v13 offset:36864
    v_cvt_pk_bf16_f32 v38, v40, v41
    v_mfma_f32_16x16x32_bf16 v[132:135], a[164:167], v[52:55], v[132:135]
    v_exp_f32 v43, v43
    v_mfma_f32_16x16x32_bf16 v[136:139], a[168:171], v[52:55], v[136:139]
    ds_read_b64_tr_b16 a[164:165], v14 offset:32768
    v_cvt_pk_bf16_f32 v39, v42, v43
    v_mfma_f32_16x16x32_bf16 v[168:171], a[168:171], v[60:63], v[168:171]
    v_exp_f32 v44, v44
    v_mfma_f32_16x16x32_bf16 v[172:175], a[172:175], v[60:63], v[172:175]
    ds_read_b64_tr_b16 a[166:167], v14 offset:36864
    v_mfma_f32_16x16x32_bf16 v[140:143], a[172:175], v[52:55], v[140:143]
    v_exp_f32 v45, v45
    v_mfma_f32_16x16x32_bf16 v[144:147], a[176:179], v[52:55], v[144:147]
    ds_read_b64_tr_b16 a[168:169], v15 offset:32768
    v_cvt_pk_bf16_f32 v44, v44, v45
    v_mfma_f32_16x16x32_bf16 v[176:179], a[176:179], v[60:63], v[176:179]
    v_exp_f32 v46, v46
    v_mfma_f32_16x16x32_bf16 v[180:183], a[180:183], v[60:63], v[180:183]
    ds_read_b64_tr_b16 a[170:171], v15 offset:36864
    v_mfma_f32_16x16x32_bf16 v[148:151], a[180:183], v[52:55], v[148:151]
    ds_read_b64_tr_b16 a[172:173], v16 offset:32768
    v_mfma_f32_16x16x32_bf16 v[152:155], a[184:187], v[52:55], v[152:155]
    v_exp_f32 v47, v47
    v_mfma_f32_16x16x32_bf16 v[184:187], a[184:187], v[60:63], v[184:187]
    ds_read_b64_tr_b16 a[174:175], v16 offset:36864
    v_cvt_pk_bf16_f32 v45, v46, v47
    v_mfma_f32_16x16x32_bf16 v[188:191], a[188:191], v[60:63], v[188:191]
    v_exp_f32 v48, v48
    v_mfma_f32_16x16x32_bf16 v[156:159], a[188:191], v[52:55], v[156:159]
    ds_read_b64_tr_b16 a[176:177], v17 offset:32768
    v_mfma_f32_16x16x32_bf16 v[52:55], a[128:131], a[64:67], 0
    v_exp_f32 v49, v49
    v_mfma_f32_16x16x32_bf16 v[52:55], a[132:135], a[68:71], v[52:55]
    ds_read_b64_tr_b16 a[178:179], v17 offset:36864
    v_cvt_pk_bf16_f32 v46, v48, v49
    v_mfma_f32_16x16x32_bf16 v[52:55], a[136:139], a[72:75], v[52:55]
    v_exp_f32 v50, v50
    v_mfma_f32_16x16x32_bf16 v[52:55], a[140:143], a[76:79], v[52:55]
    ds_read_b64_tr_b16 a[180:181], v18 offset:32768
    v_mfma_f32_16x16x32_bf16 v[56:59], a[144:147], a[64:67], 0
    ds_read_b64_tr_b16 a[182:183], v18 offset:36864
    v_mfma_f32_16x16x32_bf16 v[56:59], a[148:151], a[68:71], v[56:59]
    v_exp_f32 v51, v51
    v_mfma_f32_16x16x32_bf16 v[56:59], a[152:155], a[72:75], v[56:59]
    ds_read_b64_tr_b16 a[184:185], v19 offset:32768
    v_cvt_pk_bf16_f32 v47, v50, v51
    v_mfma_f32_16x16x32_bf16 v[56:59], a[156:159], a[76:79], v[56:59]
    v_fma_f32 v52, v52, s35, v76
    v_fma_f32 v53, v53, s35, v76
    v_mfma_f32_16x16x32_bf16 v[60:63], a[128:131], a[80:83], 0
    ds_read_b64_tr_b16 a[186:187], v19 offset:36864
    v_fma_f32 v54, v54, s35, v76
    v_mfma_f32_16x16x32_bf16 v[60:63], a[132:135], a[84:87], v[60:63]
    v_exp_f32 v52, v52
    v_mfma_f32_16x16x32_bf16 v[60:63], a[136:139], a[88:91], v[60:63]
    ds_read_b64_tr_b16 a[188:189], v20 offset:32768
    v_fma_f32 v55, v55, s35, v76
    v_mfma_f32_16x16x32_bf16 v[60:63], a[140:143], a[92:95], v[60:63]
    v_exp_f32 v53, v53
    v_mfma_f32_16x16x32_bf16 v[64:67], a[144:147], a[80:83], 0
    ds_read_b64_tr_b16 a[190:191], v20 offset:36864
    v_fma_f32 v56, v56, s35, v76
    v_mfma_f32_16x16x32_bf16 v[64:67], a[148:151], a[84:87], v[64:67]
    v_exp_f32 v54, v54
    v_mfma_f32_16x16x32_bf16 v[64:67], a[152:155], a[88:91], v[64:67]
    v_exp_f32 v55, v55
    v_mfma_f32_16x16x32_bf16 v[64:67], a[156:159], a[92:95], v[64:67]
    v_exp_f32 v56, v56
    v_mfma_f32_16x16x32_bf16 a[192:195], a[216:219], v[36:39], a[192:195]
    v_fma_f32 v57, v57, s35, v76
    v_cvt_pk_bf16_f32 v52, v52, v53
    v_mfma_f32_16x16x32_bf16 a[196:199], a[216:219], v[44:47], a[196:199]
    s_waitcnt lgkmcnt(0)
    v_fma_f32 v58, v58, s35, v76
    v_mfma_f32_16x16x32_bf16 a[0:3], a[160:163], v[36:39], a[0:3]
    v_exp_f32 v57, v57
    v_mfma_f32_16x16x32_bf16 v[96:99], a[160:163], v[44:47], v[96:99]
    v_exp_f32 v58, v58
    v_mfma_f32_16x16x32_bf16 v[100:103], a[164:167], v[44:47], v[100:103]
    v_fma_f32 v59, v59, s35, v76
    v_cvt_pk_bf16_f32 v53, v54, v55
    v_mfma_f32_16x16x32_bf16 a[4:7], a[164:167], v[36:39], a[4:7]
    v_exp_f32 v59, v59
    v_mfma_f32_16x16x32_bf16 a[8:11], a[168:171], v[36:39], a[8:11]
    v_cvt_pk_bf16_f32 v54, v56, v57
    v_cvt_pk_bf16_f32 v55, v58, v59
    v_mfma_f32_16x16x32_bf16 v[104:107], a[168:171], v[44:47], v[104:107]
    v_fma_f32 v60, v60, s35, v80
    v_fma_f32 v61, v61, s35, v80
    v_mfma_f32_16x16x32_bf16 v[108:111], a[172:175], v[44:47], v[108:111]
    v_exp_f32 v60, v60
    v_mfma_f32_16x16x32_bf16 a[12:15], a[172:175], v[36:39], a[12:15]
    s_waitcnt vmcnt(8)
    v_fma_f32 v62, v62, s35, v80
    v_mfma_f32_16x16x32_bf16 a[16:19], a[176:179], v[36:39], a[16:19]
    ds_read_b128 a[96:99], v0 offset:4352
    ds_read_b128 a[100:103], v21 offset:4352
    v_mfma_f32_16x16x32_bf16 v[112:115], a[176:179], v[44:47], v[112:115]
    ds_read_b128 a[104:107], v26 offset:4352
    ds_read_b128 a[108:111], v27 offset:4352
    v_mfma_f32_16x16x32_bf16 v[116:119], a[180:183], v[44:47], v[116:119]
    v_exp_f32 v61, v61
    v_mfma_f32_16x16x32_bf16 a[20:23], a[180:183], v[36:39], a[20:23]
    v_exp_f32 v62, v62
    v_mfma_f32_16x16x32_bf16 a[24:27], a[184:187], v[36:39], a[24:27]
    v_fma_f32 v63, v63, s35, v80
    v_fma_f32 v64, v64, s35, v80
    v_mfma_f32_16x16x32_bf16 v[120:123], a[184:187], v[44:47], v[120:123]
    v_exp_f32 v63, v63
    v_mfma_f32_16x16x32_bf16 v[124:127], a[188:191], v[44:47], v[124:127]
    v_exp_f32 v64, v64
    v_mfma_f32_16x16x32_bf16 a[28:31], a[188:191], v[36:39], a[28:31]
    s_waitcnt vmcnt(4)
    v_fma_f32 v65, v65, s35, v80
    s_waitcnt lgkmcnt(3)
    v_mfma_f32_16x16x32_bf16 v[36:39], a[128:131], a[96:99], 0
    ds_read_b128 a[112:115], v0 offset:8704
    ds_read_b128 a[116:119], v21 offset:8704
    s_waitcnt lgkmcnt(4)
    v_mfma_f32_16x16x32_bf16 v[36:39], a[132:135], a[100:103], v[36:39]
    ds_read_b128 a[120:123], v26 offset:8704
    ds_read_b128 a[124:127], v27 offset:8704
    s_waitcnt lgkmcnt(5)
    v_mfma_f32_16x16x32_bf16 v[36:39], a[136:139], a[104:107], v[36:39]
    v_exp_f32 v65, v65
    s_waitcnt lgkmcnt(4)
    v_mfma_f32_16x16x32_bf16 v[36:39], a[140:143], a[108:111], v[36:39]
    v_cvt_pk_bf16_f32 v60, v60, v61
    v_fma_f32 v66, v66, s35, v80
    v_mfma_f32_16x16x32_bf16 v[40:43], a[144:147], a[96:99], 0
    v_exp_f32 v66, v66
    v_mfma_f32_16x16x32_bf16 v[40:43], a[148:151], a[100:103], v[40:43]
    v_fma_f32 v67, v67, s35, v80
    v_cvt_pk_bf16_f32 v61, v62, v63
    v_mfma_f32_16x16x32_bf16 v[40:43], a[152:155], a[104:107], v[40:43]
    v_exp_f32 v67, v67
    v_mfma_f32_16x16x32_bf16 v[40:43], a[156:159], a[108:111], v[40:43]
    s_waitcnt vmcnt(0)
    s_barrier
    s_waitcnt lgkmcnt(3)
    v_mfma_f32_16x16x32_bf16 v[44:47], a[128:131], a[112:115], 0
    ds_read_b128 a[128:131], v9 offset:40960
    s_add_u32 m0, s33, 32768
    s_waitcnt lgkmcnt(3)
    v_mfma_f32_16x16x32_bf16 v[44:47], a[132:135], a[116:119], v[44:47]
    buffer_load_dwordx4 v2, s[16:19], s46 offen offset:0 nt lds
    v_cvt_pk_bf16_f32 v62, v64, v65
    s_waitcnt lgkmcnt(2)
    v_mfma_f32_16x16x32_bf16 v[44:47], a[136:139], a[120:123], v[44:47]
    ds_read_b128 a[132:135], v10 offset:40960
    v_cvt_pk_bf16_f32 v63, v66, v67
    s_waitcnt lgkmcnt(2)
    v_mfma_f32_16x16x32_bf16 v[44:47], a[140:143], a[124:127], v[44:47]
    v_max3_f32 v22, v36, v37, v38
    v_max3_f32 v23, v39, v40, v41
    v_mfma_f32_16x16x32_bf16 v[48:51], a[144:147], a[112:115], 0
    v_max3_f32 v22, v22, v42, v43
    v_max_f32 v22, v22, v23
    v_mfma_f32_16x16x32_bf16 v[48:51], a[148:151], a[116:119], v[48:51]
    ds_read_b128 a[136:139], v11 offset:40960
    buffer_load_dwordx4 v3, s[16:19], s46 offen offset:1024 nt lds
    v_mfma_f32_16x16x32_bf16 v[48:51], a[152:155], a[120:123], v[48:51]
    s_add_u32 m0, s34, 32768
    v_mov_b32 v23, v22
    v_mfma_f32_16x16x32_bf16 v[48:51], a[156:159], a[124:127], v[48:51]
    v_mfma_f32_16x16x32_bf16 a[200:203], a[216:219], v[52:55], a[200:203]
    ds_read_b128 a[140:143], v12 offset:40960
    v_permlane32_swap_b32 v22, v23
    v_mfma_f32_16x16x32_bf16 a[204:207], a[216:219], v[60:63], a[204:207]
    buffer_load_dwordx4 v4, s[20:23], s46 offen offset:0 nt lds
    v_max_f32 v22, v22, v23
    v_mfma_f32_16x16x32_bf16 v[128:131], a[160:163], v[52:55], v[128:131]
    ds_read_b128 a[144:147], v9 offset:45056
    v_mov_b32 v23, v22
    v_mfma_f32_16x16x32_bf16 v[160:163], a[160:163], v[60:63], v[160:163]
    v_mfma_f32_16x16x32_bf16 v[164:167], a[164:167], v[60:63], v[164:167]
    v_permlane16_swap_b32 v22, v23
    v_max_f32 v22, v22, v23
    v_mfma_f32_16x16x32_bf16 v[132:135], a[164:167], v[52:55], v[132:135]
    ds_read_b128 a[148:151], v10 offset:45056
    buffer_load_dwordx4 v5, s[20:23], s46 offen offset:1024 nt lds
    v_mfma_f32_16x16x32_bf16 v[136:139], a[168:171], v[52:55], v[136:139]
    v_mul_f32 v84, s37, v22
    v_fma_f32 v36, v36, s35, v84
    v_mfma_f32_16x16x32_bf16 v[168:171], a[168:171], v[60:63], v[168:171]
    v_exp_f32 v36, v36
    v_mfma_f32_16x16x32_bf16 v[172:175], a[172:175], v[60:63], v[172:175]
    ds_read_b128 a[152:155], v11 offset:45056
    v_fma_f32 v37, v37, s35, v84
    v_mfma_f32_16x16x32_bf16 v[140:143], a[172:175], v[52:55], v[140:143]
    v_exp_f32 v37, v37
    v_mfma_f32_16x16x32_bf16 v[144:147], a[176:179], v[52:55], v[144:147]
    v_fma_f32 v38, v38, s35, v84
    v_fma_f32 v39, v39, s35, v84
    v_mfma_f32_16x16x32_bf16 v[176:179], a[176:179], v[60:63], v[176:179]
    ds_read_b128 a[156:159], v12 offset:45056
    v_fma_f32 v40, v40, s35, v84
    v_mfma_f32_16x16x32_bf16 v[180:183], a[180:183], v[60:63], v[180:183]
    v_exp_f32 v38, v38
    v_mfma_f32_16x16x32_bf16 v[148:151], a[180:183], v[52:55], v[148:151]
    v_exp_f32 v39, v39
    v_mfma_f32_16x16x32_bf16 v[152:155], a[184:187], v[52:55], v[152:155]
    v_exp_f32 v40, v40
    v_mfma_f32_16x16x32_bf16 v[184:187], a[184:187], v[60:63], v[184:187]
    v_fma_f32 v41, v41, s35, v84
    v_cvt_pk_bf16_f32 v36, v36, v37
    v_mfma_f32_16x16x32_bf16 v[188:191], a[188:191], v[60:63], v[188:191]
    v_exp_f32 v41, v41
    v_mfma_f32_16x16x32_bf16 v[156:159], a[188:191], v[52:55], v[156:159]
    s_waitcnt lgkmcnt(0)
    v_fma_f32 v42, v42, s35, v84
    v_mfma_f32_16x16x32_bf16 v[52:55], a[128:131], a[32:35], v[68:71]
    v_exp_f32 v42, v42
    v_mfma_f32_16x16x32_bf16 v[52:55], a[132:135], a[36:39], v[52:55]
    v_fma_f32 v43, v43, s35, v84
    v_cvt_pk_bf16_f32 v37, v38, v39
    v_mfma_f32_16x16x32_bf16 v[52:55], a[136:139], a[40:43], v[52:55]
    v_exp_f32 v43, v43
    v_mfma_f32_16x16x32_bf16 v[52:55], a[140:143], a[44:47], v[52:55]
    v_cvt_pk_bf16_f32 v38, v40, v41
    v_cvt_pk_bf16_f32 v39, v42, v43
    v_mfma_f32_16x16x32_bf16 v[56:59], a[144:147], a[32:35], v[68:71]
    v_max3_f32 v22, v44, v45, v46
    v_max3_f32 v23, v47, v48, v49
    v_mfma_f32_16x16x32_bf16 v[56:59], a[148:151], a[36:39], v[56:59]
    v_max3_f32 v22, v22, v50, v51
    v_max_f32 v22, v22, v23
    v_mfma_f32_16x16x32_bf16 v[56:59], a[152:155], a[40:43], v[56:59]
    v_mov_b32 v23, v22
    v_mfma_f32_16x16x32_bf16 v[56:59], a[156:159], a[44:47], v[56:59]
    v_exp_f32 v52, v52
    v_mfma_f32_16x16x32_bf16 v[60:63], a[128:131], a[48:51], v[72:75]
    v_permlane32_swap_b32 v22, v23
    v_max_f32 v22, v22, v23
    v_mfma_f32_16x16x32_bf16 v[60:63], a[132:135], a[52:55], v[60:63]
    v_mov_b32 v23, v22
    v_mfma_f32_16x16x32_bf16 v[60:63], a[136:139], a[56:59], v[60:63]
    v_exp_f32 v53, v53
    v_mfma_f32_16x16x32_bf16 v[60:63], a[140:143], a[60:63], v[60:63]
    v_permlane16_swap_b32 v22, v23
    v_max_f32 v22, v22, v23
    v_mfma_f32_16x16x32_bf16 v[64:67], a[144:147], a[48:51], v[72:75]
    v_mul_f32 v88, s37, v22
    v_fma_f32 v44, v44, s35, v88
    v_mfma_f32_16x16x32_bf16 v[64:67], a[148:151], a[52:55], v[64:67]
    v_exp_f32 v44, v44
    v_mfma_f32_16x16x32_bf16 v[64:67], a[152:155], a[56:59], v[64:67]
    v_fma_f32 v45, v45, s35, v88
    v_fma_f32 v46, v46, s35, v88
    v_mfma_f32_16x16x32_bf16 v[64:67], a[156:159], a[60:63], v[64:67]
    v_fma_f32 v47, v47, s35, v88
    v_fma_f32 v48, v48, s35, v88
    v_mfma_f32_16x16x32_bf16 a[208:211], a[216:219], v[36:39], 0
    v_exp_f32 v45, v45
    v_fma_f32 v49, v49, s35, v88
    v_cvt_pk_bf16_f32 v44, v44, v45
    v_exp_f32 v46, v46
    v_exp_f32 v47, v47
    v_fma_f32 v50, v50, s35, v88
    v_fma_f32 v51, v51, s35, v88
    v_cvt_pk_bf16_f32 v45, v46, v47
    v_exp_f32 v48, v48
    v_exp_f32 v49, v49
    v_exp_f32 v50, v50
    v_cvt_pk_bf16_f32 v46, v48, v49
    v_exp_f32 v51, v51
    v_cvt_pk_bf16_f32 v52, v52, v53
    v_cvt_pk_bf16_f32 v47, v50, v51
    s_nop 1
    v_mfma_f32_16x16x32_bf16 a[212:215], a[216:219], v[44:47], 0
    v_exp_f32 v54, v54
    v_mfma_f32_16x16x32_bf16 v[192:195], a[160:163], v[36:39], 0
    v_exp_f32 v55, v55
    v_mfma_f32_16x16x32_bf16 v[224:227], a[160:163], v[44:47], 0
    ds_read_b64_tr_b16 a[160:161], v13 offset:40960
    v_cvt_pk_bf16_f32 v53, v54, v55
    v_mfma_f32_16x16x32_bf16 v[228:231], a[164:167], v[44:47], 0
    ds_read_b64_tr_b16 a[162:163], v13 offset:45056
    v_mfma_f32_16x16x32_bf16 v[196:199], a[164:167], v[36:39], 0
    v_exp_f32 v56, v56
    v_mfma_f32_16x16x32_bf16 v[200:203], a[168:171], v[36:39], 0
    ds_read_b64_tr_b16 a[164:165], v14 offset:40960
    v_mfma_f32_16x16x32_bf16 v[232:235], a[168:171], v[44:47], 0
    v_exp_f32 v57, v57
    v_mfma_f32_16x16x32_bf16 v[236:239], a[172:175], v[44:47], 0
    ds_read_b64_tr_b16 a[166:167], v14 offset:45056
    v_cvt_pk_bf16_f32 v54, v56, v57
    v_mfma_f32_16x16x32_bf16 v[204:207], a[172:175], v[36:39], 0
    v_exp_f32 v58, v58
    v_mfma_f32_16x16x32_bf16 v[208:211], a[176:179], v[36:39], 0
    ds_read_b64_tr_b16 a[168:169], v15 offset:40960
    v_mfma_f32_16x16x32_bf16 v[240:243], a[176:179], v[44:47], 0
    v_exp_f32 v59, v59
    v_mfma_f32_16x16x32_bf16 v[244:247], a[180:183], v[44:47], 0
    ds_read_b64_tr_b16 a[170:171], v15 offset:45056
    v_cvt_pk_bf16_f32 v55, v58, v59
    v_mfma_f32_16x16x32_bf16 v[212:215], a[180:183], v[36:39], 0
    ds_read_b64_tr_b16 a[172:173], v16 offset:40960
    v_mfma_f32_16x16x32_bf16 v[216:219], a[184:187], v[36:39], 0
    v_exp_f32 v60, v60
    v_mfma_f32_16x16x32_bf16 v[248:251], a[184:187], v[44:47], 0
    ds_read_b64_tr_b16 a[174:175], v16 offset:45056
    v_mfma_f32_16x16x32_bf16 v[252:255], a[188:191], v[44:47], 0
    v_exp_f32 v61, v61
    v_mfma_f32_16x16x32_bf16 v[220:223], a[188:191], v[36:39], 0
    ds_read_b64_tr_b16 a[176:177], v17 offset:40960
    v_cvt_pk_bf16_f32 v60, v60, v61
    v_mfma_f32_16x16x32_bf16 v[36:39], a[128:131], a[64:67], 0
    v_exp_f32 v62, v62
    v_mfma_f32_16x16x32_bf16 v[36:39], a[132:135], a[68:71], v[36:39]
    ds_read_b64_tr_b16 a[178:179], v17 offset:45056
    v_mfma_f32_16x16x32_bf16 v[36:39], a[136:139], a[72:75], v[36:39]
    v_exp_f32 v63, v63
    v_mfma_f32_16x16x32_bf16 v[36:39], a[140:143], a[76:79], v[36:39]
    ds_read_b64_tr_b16 a[180:181], v18 offset:40960
    v_cvt_pk_bf16_f32 v61, v62, v63
    v_mfma_f32_16x16x32_bf16 v[40:43], a[144:147], a[64:67], 0
    ds_read_b64_tr_b16 a[182:183], v18 offset:45056
    v_mfma_f32_16x16x32_bf16 v[40:43], a[148:151], a[68:71], v[40:43]
    v_exp_f32 v64, v64
    v_mfma_f32_16x16x32_bf16 v[40:43], a[152:155], a[72:75], v[40:43]
    ds_read_b64_tr_b16 a[184:185], v19 offset:40960
    v_fma_f32 v36, v36, s35, v76
    v_mfma_f32_16x16x32_bf16 v[40:43], a[156:159], a[76:79], v[40:43]
    v_exp_f32 v65, v65
    v_mfma_f32_16x16x32_bf16 v[44:47], a[128:131], a[80:83], 0
    ds_read_b64_tr_b16 a[186:187], v19 offset:45056
    v_cvt_pk_bf16_f32 v62, v64, v65
    v_mfma_f32_16x16x32_bf16 v[44:47], a[132:135], a[84:87], v[44:47]
    v_exp_f32 v66, v66
    v_mfma_f32_16x16x32_bf16 v[44:47], a[136:139], a[88:91], v[44:47]
    ds_read_b64_tr_b16 a[188:189], v20 offset:40960
    v_fma_f32 v37, v37, s35, v76
    v_mfma_f32_16x16x32_bf16 v[44:47], a[140:143], a[92:95], v[44:47]
    v_exp_f32 v67, v67
    v_mfma_f32_16x16x32_bf16 v[48:51], a[144:147], a[80:83], 0
    ds_read_b64_tr_b16 a[190:191], v20 offset:45056
    v_cvt_pk_bf16_f32 v63, v66, v67
    v_mfma_f32_16x16x32_bf16 v[48:51], a[148:151], a[84:87], v[48:51]
    v_exp_f32 v36, v36
    v_mfma_f32_16x16x32_bf16 v[48:51], a[152:155], a[88:91], v[48:51]
    v_exp_f32 v37, v37
    v_mfma_f32_16x16x32_bf16 v[48:51], a[156:159], a[92:95], v[48:51]
    v_fma_f32 v38, v38, s35, v76
    v_fma_f32 v39, v39, s35, v76
    v_mfma_f32_16x16x32_bf16 a[192:195], a[216:219], v[52:55], a[192:195]
    v_exp_f32 v38, v38
    v_mfma_f32_16x16x32_bf16 a[196:199], a[216:219], v[60:63], a[196:199]
    s_waitcnt lgkmcnt(0)
    v_fma_f32 v40, v40, s35, v76
    v_mfma_f32_16x16x32_bf16 a[0:3], a[160:163], v[52:55], a[0:3]
    v_exp_f32 v39, v39
    v_mfma_f32_16x16x32_bf16 v[96:99], a[160:163], v[60:63], v[96:99]
    v_exp_f32 v40, v40
    v_mfma_f32_16x16x32_bf16 v[100:103], a[164:167], v[60:63], v[100:103]
    v_fma_f32 v41, v41, s35, v76
    v_cvt_pk_bf16_f32 v36, v36, v37
    v_mfma_f32_16x16x32_bf16 a[4:7], a[164:167], v[52:55], a[4:7]
    v_exp_f32 v41, v41
    v_mfma_f32_16x16x32_bf16 a[8:11], a[168:171], v[52:55], a[8:11]
    v_fma_f32 v42, v42, s35, v76
    v_fma_f32 v43, v43, s35, v76
    v_mfma_f32_16x16x32_bf16 v[104:107], a[168:171], v[60:63], v[104:107]
    v_exp_f32 v42, v42
    v_mfma_f32_16x16x32_bf16 v[108:111], a[172:175], v[60:63], v[108:111]
    v_exp_f32 v43, v43
    v_mfma_f32_16x16x32_bf16 a[12:15], a[172:175], v[52:55], a[12:15]
    v_cvt_pk_bf16_f32 v37, v38, v39
    v_cvt_pk_bf16_f32 v38, v40, v41
    v_mfma_f32_16x16x32_bf16 a[16:19], a[176:179], v[52:55], a[16:19]
    v_cvt_pk_bf16_f32 v39, v42, v43
    v_fma_f32 v44, v44, s35, v80
    v_mfma_f32_16x16x32_bf16 v[112:115], a[176:179], v[60:63], v[112:115]
    v_exp_f32 v44, v44
    v_mfma_f32_16x16x32_bf16 v[116:119], a[180:183], v[60:63], v[116:119]
    v_fma_f32 v45, v45, s35, v80
    v_fma_f32 v46, v46, s35, v80
    v_mfma_f32_16x16x32_bf16 a[20:23], a[180:183], v[52:55], a[20:23]
    v_exp_f32 v45, v45
    v_mfma_f32_16x16x32_bf16 a[24:27], a[184:187], v[52:55], a[24:27]
    v_exp_f32 v46, v46
    v_mfma_f32_16x16x32_bf16 v[120:123], a[184:187], v[60:63], v[120:123]
    v_fma_f32 v47, v47, s35, v80
    v_fma_f32 v48, v48, s35, v80
    v_mfma_f32_16x16x32_bf16 v[124:127], a[188:191], v[60:63], v[124:127]
    v_exp_f32 v47, v47
    v_mfma_f32_16x16x32_bf16 a[28:31], a[188:191], v[52:55], a[28:31]
    v_exp_f32 v48, v48
    v_mfma_f32_16x16x32_bf16 v[52:55], a[128:131], a[96:99], 0
    v_fma_f32 v49, v49, s35, v80
    v_cvt_pk_bf16_f32 v44, v44, v45
    v_mfma_f32_16x16x32_bf16 v[52:55], a[132:135], a[100:103], v[52:55]
    v_exp_f32 v49, v49
    v_mfma_f32_16x16x32_bf16 v[52:55], a[136:139], a[104:107], v[52:55]
    v_fma_f32 v50, v50, s35, v80
    v_fma_f32 v51, v51, s35, v80
    v_mfma_f32_16x16x32_bf16 v[52:55], a[140:143], a[108:111], v[52:55]
    v_exp_f32 v50, v50
    v_mfma_f32_16x16x32_bf16 v[56:59], a[144:147], a[96:99], 0
    v_exp_f32 v51, v51
    v_mfma_f32_16x16x32_bf16 v[56:59], a[148:151], a[100:103], v[56:59]
    v_cvt_pk_bf16_f32 v45, v46, v47
    v_cvt_pk_bf16_f32 v46, v48, v49
    v_mfma_f32_16x16x32_bf16 v[56:59], a[152:155], a[104:107], v[56:59]
    v_cvt_pk_bf16_f32 v47, v50, v51
    v_fma_f32 v52, v52, s35, v84
    v_mfma_f32_16x16x32_bf16 v[56:59], a[156:159], a[108:111], v[56:59]
    s_waitcnt vmcnt(0)
    s_barrier
    v_mfma_f32_16x16x32_bf16 v[60:63], a[128:131], a[112:115], 0
    ds_read_b128 a[128:131], v9 offset:32768
    s_add_u32 m0, s33, 40960
    v_mfma_f32_16x16x32_bf16 v[60:63], a[132:135], a[116:119], v[60:63]
    buffer_load_dwordx4 v2, s[16:19], s47 offen offset:0 nt lds
    v_fma_f32 v53, v53, s35, v84
    v_mfma_f32_16x16x32_bf16 v[60:63], a[136:139], a[120:123], v[60:63]
    ds_read_b128 a[132:135], v10 offset:32768
    v_fma_f32 v54, v54, s35, v84
    v_mfma_f32_16x16x32_bf16 v[60:63], a[140:143], a[124:127], v[60:63]
    v_exp_f32 v52, v52
    v_mfma_f32_16x16x32_bf16 v[64:67], a[144:147], a[112:115], 0
    v_exp_f32 v53, v53
    v_mfma_f32_16x16x32_bf16 v[64:67], a[148:151], a[116:119], v[64:67]
    ds_read_b128 a[136:139], v11 offset:32768
    buffer_load_dwordx4 v3, s[16:19], s47 offen offset:1024 nt lds
    v_mfma_f32_16x16x32_bf16 v[64:67], a[152:155], a[120:123], v[64:67]
    s_add_u32 m0, s34, 40960
    v_fma_f32 v55, v55, s35, v84
    v_mfma_f32_16x16x32_bf16 v[64:67], a[156:159], a[124:127], v[64:67]
    v_exp_f32 v54, v54
    v_mfma_f32_16x16x32_bf16 a[200:203], a[216:219], v[36:39], a[200:203]
    ds_read_b128 a[140:143], v12 offset:32768
    v_fma_f32 v56, v56, s35, v84
    v_mfma_f32_16x16x32_bf16 a[204:207], a[216:219], v[44:47], a[204:207]
    buffer_load_dwordx4 v4, s[20:23], s47 offen offset:0 nt lds
    v_fma_f32 v57, v57, s35, v84
    v_mfma_f32_16x16x32_bf16 v[128:131], a[160:163], v[36:39], v[128:131]
    ds_read_b128 a[144:147], v9 offset:36864
    v_cvt_pk_bf16_f32 v52, v52, v53
    v_mfma_f32_16x16x32_bf16 v[160:163], a[160:163], v[44:47], v[160:163]
    v_exp_f32 v55, v55
    v_mfma_f32_16x16x32_bf16 v[164:167], a[164:167], v[44:47], v[164:167]
    v_exp_f32 v56, v56
    v_mfma_f32_16x16x32_bf16 v[132:135], a[164:167], v[36:39], v[132:135]
    ds_read_b128 a[148:151], v10 offset:36864
    buffer_load_dwordx4 v5, s[20:23], s47 offen offset:1024 nt lds
    v_mfma_f32_16x16x32_bf16 v[136:139], a[168:171], v[36:39], v[136:139]
    v_exp_f32 v57, v57
    v_mfma_f32_16x16x32_bf16 v[168:171], a[168:171], v[44:47], v[168:171]
    v_fma_f32 v58, v58, s35, v84
    v_fma_f32 v59, v59, s35, v84
    v_mfma_f32_16x16x32_bf16 v[172:175], a[172:175], v[44:47], v[172:175]
    ds_read_b128 a[152:155], v11 offset:36864
    v_cvt_pk_bf16_f32 v53, v54, v55
    v_mfma_f32_16x16x32_bf16 v[140:143], a[172:175], v[36:39], v[140:143]
    v_exp_f32 v58, v58
    v_mfma_f32_16x16x32_bf16 v[144:147], a[176:179], v[36:39], v[144:147]
    v_exp_f32 v59, v59
    v_mfma_f32_16x16x32_bf16 v[176:179], a[176:179], v[44:47], v[176:179]
    ds_read_b128 a[156:159], v12 offset:36864
    v_cvt_pk_bf16_f32 v54, v56, v57
    v_mfma_f32_16x16x32_bf16 v[180:183], a[180:183], v[44:47], v[180:183]
    v_cvt_pk_bf16_f32 v55, v58, v59
    v_fma_f32 v60, v60, s35, v88
    v_mfma_f32_16x16x32_bf16 v[148:151], a[180:183], v[36:39], v[148:151]
    v_exp_f32 v60, v60
    v_mfma_f32_16x16x32_bf16 v[152:155], a[184:187], v[36:39], v[152:155]
    v_fma_f32 v61, v61, s35, v88
    v_fma_f32 v62, v62, s35, v88
    v_mfma_f32_16x16x32_bf16 v[184:187], a[184:187], v[44:47], v[184:187]
    v_exp_f32 v61, v61
    v_mfma_f32_16x16x32_bf16 v[188:191], a[188:191], v[44:47], v[188:191]
    v_exp_f32 v62, v62
    v_mfma_f32_16x16x32_bf16 v[156:159], a[188:191], v[36:39], v[156:159]
    s_waitcnt lgkmcnt(0)
    v_fma_f32 v63, v63, s35, v88
    v_mfma_f32_16x16x32_bf16 v[36:39], a[128:131], a[32:35], v[68:71]
    v_exp_f32 v63, v63
    v_mfma_f32_16x16x32_bf16 v[36:39], a[132:135], a[36:39], v[36:39]
    v_fma_f32 v64, v64, s35, v88
    v_fma_f32 v65, v65, s35, v88
    v_mfma_f32_16x16x32_bf16 v[36:39], a[136:139], a[40:43], v[36:39]
    v_exp_f32 v64, v64
    v_mfma_f32_16x16x32_bf16 v[36:39], a[140:143], a[44:47], v[36:39]
    v_exp_f32 v65, v65
    v_mfma_f32_16x16x32_bf16 v[40:43], a[144:147], a[32:35], v[68:71]
    v_cvt_pk_bf16_f32 v60, v60, v61
    v_fma_f32 v66, v66, s35, v88
    v_mfma_f32_16x16x32_bf16 v[40:43], a[148:151], a[36:39], v[40:43]
    v_exp_f32 v66, v66
    v_mfma_f32_16x16x32_bf16 v[40:43], a[152:155], a[40:43], v[40:43]
    v_fma_f32 v67, v67, s35, v88
    v_cvt_pk_bf16_f32 v61, v62, v63
    v_mfma_f32_16x16x32_bf16 v[40:43], a[156:159], a[44:47], v[40:43]
    v_exp_f32 v67, v67
    v_mfma_f32_16x16x32_bf16 v[44:47], a[128:131], a[48:51], v[72:75]
    v_exp_f32 v36, v36
    v_mfma_f32_16x16x32_bf16 v[44:47], a[132:135], a[52:55], v[44:47]
    v_exp_f32 v37, v37
    v_mfma_f32_16x16x32_bf16 v[44:47], a[136:139], a[56:59], v[44:47]
    v_exp_f32 v38, v38
    v_mfma_f32_16x16x32_bf16 v[44:47], a[140:143], a[60:63], v[44:47]
    v_exp_f32 v39, v39
    v_mfma_f32_16x16x32_bf16 v[48:51], a[144:147], a[48:51], v[72:75]
    v_exp_f32 v40, v40
    v_mfma_f32_16x16x32_bf16 v[48:51], a[148:151], a[52:55], v[48:51]
    v_exp_f32 v41, v41
    v_mfma_f32_16x16x32_bf16 v[48:51], a[152:155], a[56:59], v[48:51]
    v_cvt_pk_bf16_f32 v62, v64, v65
    v_cvt_pk_bf16_f32 v63, v66, v67
    v_mfma_f32_16x16x32_bf16 v[48:51], a[156:159], a[60:63], v[48:51]
    v_exp_f32 v42, v42
    v_mfma_f32_16x16x32_bf16 a[208:211], a[216:219], v[52:55], a[208:211]
    v_exp_f32 v43, v43
    v_mfma_f32_16x16x32_bf16 a[212:215], a[216:219], v[60:63], a[212:215]
    v_exp_f32 v44, v44
    v_mfma_f32_16x16x32_bf16 v[192:195], a[160:163], v[52:55], v[192:195]
    v_exp_f32 v45, v45
    v_mfma_f32_16x16x32_bf16 v[224:227], a[160:163], v[60:63], v[224:227]
    ds_read_b64_tr_b16 a[160:161], v13 offset:32768
    v_cvt_pk_bf16_f32 v36, v36, v37
    v_mfma_f32_16x16x32_bf16 v[228:231], a[164:167], v[60:63], v[228:231]
    ds_read_b64_tr_b16 a[162:163], v13 offset:36864
    v_cvt_pk_bf16_f32 v37, v38, v39
    v_mfma_f32_16x16x32_bf16 v[196:199], a[164:167], v[52:55], v[196:199]
    v_exp_f32 v46, v46
    v_mfma_f32_16x16x32_bf16 v[200:203], a[168:171], v[52:55], v[200:203]
    ds_read_b64_tr_b16 a[164:165], v14 offset:32768
    v_cvt_pk_bf16_f32 v38, v40, v41
    v_mfma_f32_16x16x32_bf16 v[232:235], a[168:171], v[60:63], v[232:235]
    v_exp_f32 v47, v47
    v_mfma_f32_16x16x32_bf16 v[236:239], a[172:175], v[60:63], v[236:239]
    ds_read_b64_tr_b16 a[166:167], v14 offset:36864
    v_cvt_pk_bf16_f32 v39, v42, v43
    v_mfma_f32_16x16x32_bf16 v[204:207], a[172:175], v[52:55], v[204:207]
    v_exp_f32 v48, v48
    v_mfma_f32_16x16x32_bf16 v[208:211], a[176:179], v[52:55], v[208:211]
    ds_read_b64_tr_b16 a[168:169], v15 offset:32768
    v_cvt_pk_bf16_f32 v44, v44, v45
    v_mfma_f32_16x16x32_bf16 v[240:243], a[176:179], v[60:63], v[240:243]
    v_exp_f32 v49, v49
    v_mfma_f32_16x16x32_bf16 v[244:247], a[180:183], v[60:63], v[244:247]
    ds_read_b64_tr_b16 a[170:171], v15 offset:36864
    v_cvt_pk_bf16_f32 v45, v46, v47
    v_mfma_f32_16x16x32_bf16 v[212:215], a[180:183], v[52:55], v[212:215]
    ds_read_b64_tr_b16 a[172:173], v16 offset:32768
    v_cvt_pk_bf16_f32 v46, v48, v49
    v_mfma_f32_16x16x32_bf16 v[216:219], a[184:187], v[52:55], v[216:219]
    v_exp_f32 v50, v50
    v_mfma_f32_16x16x32_bf16 v[248:251], a[184:187], v[60:63], v[248:251]
    ds_read_b64_tr_b16 a[174:175], v16 offset:36864
    v_mfma_f32_16x16x32_bf16 v[252:255], a[188:191], v[60:63], v[252:255]
    v_exp_f32 v51, v51
    v_mfma_f32_16x16x32_bf16 v[220:223], a[188:191], v[52:55], v[220:223]
    ds_read_b64_tr_b16 a[176:177], v17 offset:32768
    v_cvt_pk_bf16_f32 v47, v50, v51
    v_mfma_f32_16x16x32_bf16 v[52:55], a[128:131], a[64:67], 0
    v_mfma_f32_16x16x32_bf16 v[52:55], a[132:135], a[68:71], v[52:55]
    ds_read_b64_tr_b16 a[178:179], v17 offset:36864
    v_mfma_f32_16x16x32_bf16 v[52:55], a[136:139], a[72:75], v[52:55]
.p2align 3
Lsteady:
    v_mfma_f32_16x16x32_bf16 v[52:55], a[140:143], a[76:79], v[52:55]
    ds_read_b64_tr_b16 a[180:181], v18 offset:32768
    v_mfma_f32_16x16x32_bf16 v[56:59], a[144:147], a[64:67], 0
    ds_read_b64_tr_b16 a[182:183], v18 offset:36864
    v_mfma_f32_16x16x32_bf16 v[56:59], a[148:151], a[68:71], v[56:59]
    v_mfma_f32_16x16x32_bf16 v[56:59], a[152:155], a[72:75], v[56:59]
    ds_read_b64_tr_b16 a[184:185], v19 offset:32768
    v_mfma_f32_16x16x32_bf16 v[56:59], a[156:159], a[76:79], v[56:59]
    v_mfma_f32_16x16x32_bf16 v[60:63], a[128:131], a[80:83], 0
    ds_read_b64_tr_b16 a[186:187], v19 offset:36864
    v_fma_f32 v52, v52, s35, v76
    v_mfma_f32_16x16x32_bf16 v[60:63], a[132:135], a[84:87], v[60:63]
    v_exp_f32 v52, v52
    v_mfma_f32_16x16x32_bf16 v[60:63], a[136:139], a[88:91], v[60:63]
    ds_read_b64_tr_b16 a[188:189], v20 offset:32768
    v_fma_f32 v53, v53, s35, v76
    v_mfma_f32_16x16x32_bf16 v[60:63], a[140:143], a[92:95], v[60:63]
    v_exp_f32 v53, v53
    v_mfma_f32_16x16x32_bf16 v[64:67], a[144:147], a[80:83], 0
    ds_read_b64_tr_b16 a[190:191], v20 offset:36864
    v_fma_f32 v54, v54, s35, v76
    v_mfma_f32_16x16x32_bf16 v[64:67], a[148:151], a[84:87], v[64:67]
    v_exp_f32 v54, v54
    v_mfma_f32_16x16x32_bf16 v[64:67], a[152:155], a[88:91], v[64:67]
    v_fma_f32 v55, v55, s35, v76
    v_fma_f32 v56, v56, s35, v76
    v_mfma_f32_16x16x32_bf16 v[64:67], a[156:159], a[92:95], v[64:67]
    v_exp_f32 v55, v55
    v_mfma_f32_16x16x32_bf16 a[192:195], a[216:219], v[36:39], a[192:195]
    v_exp_f32 v56, v56
    v_mfma_f32_16x16x32_bf16 a[196:199], a[216:219], v[44:47], a[196:199]
    s_waitcnt lgkmcnt(0)
    v_fma_f32 v57, v57, s35, v76
    v_mfma_f32_16x16x32_bf16 a[0:3], a[160:163], v[36:39], a[0:3]
    v_exp_f32 v57, v57
    v_mfma_f32_16x16x32_bf16 v[96:99], a[160:163], v[44:47], v[96:99]
    v_cvt_pk_bf16_f32 v52, v52, v53
    v_fma_f32 v58, v58, s35, v76
    v_mfma_f32_16x16x32_bf16 v[100:103], a[164:167], v[44:47], v[100:103]
    v_exp_f32 v58, v58
    v_mfma_f32_16x16x32_bf16 a[4:7], a[164:167], v[36:39], a[4:7]
    v_fma_f32 v59, v59, s35, v76
    v_cvt_pk_bf16_f32 v53, v54, v55
    v_mfma_f32_16x16x32_bf16 a[8:11], a[168:171], v[36:39], a[8:11]
    v_exp_f32 v59, v59
    v_mfma_f32_16x16x32_bf16 v[104:107], a[168:171], v[44:47], v[104:107]
    v_cvt_pk_bf16_f32 v54, v56, v57
    v_cvt_pk_bf16_f32 v55, v58, v59
    v_mfma_f32_16x16x32_bf16 v[108:111], a[172:175], v[44:47], v[108:111]
    v_fma_f32 v60, v60, s35, v80
    v_fma_f32 v61, v61, s35, v80
    v_mfma_f32_16x16x32_bf16 a[12:15], a[172:175], v[36:39], a[12:15]
    v_exp_f32 v60, v60
    v_mfma_f32_16x16x32_bf16 a[16:19], a[176:179], v[36:39], a[16:19]
    v_exp_f32 v61, v61
    v_mfma_f32_16x16x32_bf16 v[112:115], a[176:179], v[44:47], v[112:115]
    v_fma_f32 v62, v62, s35, v80
    v_fma_f32 v63, v63, s35, v80
    v_mfma_f32_16x16x32_bf16 v[116:119], a[180:183], v[44:47], v[116:119]
    v_exp_f32 v62, v62
    v_mfma_f32_16x16x32_bf16 a[20:23], a[180:183], v[36:39], a[20:23]
    v_exp_f32 v63, v63
    v_mfma_f32_16x16x32_bf16 a[24:27], a[184:187], v[36:39], a[24:27]
    v_fma_f32 v64, v64, s35, v80
    v_fma_f32 v65, v65, s35, v80
    v_mfma_f32_16x16x32_bf16 v[120:123], a[184:187], v[44:47], v[120:123]
    v_exp_f32 v64, v64
    v_mfma_f32_16x16x32_bf16 v[124:127], a[188:191], v[44:47], v[124:127]
    v_exp_f32 v65, v65
    v_mfma_f32_16x16x32_bf16 a[28:31], a[188:191], v[36:39], a[28:31]
    v_cvt_pk_bf16_f32 v60, v60, v61
    v_fma_f32 v66, v66, s35, v80
    v_mfma_f32_16x16x32_bf16 v[36:39], a[128:131], a[96:99], 0
    v_exp_f32 v66, v66
    v_mfma_f32_16x16x32_bf16 v[36:39], a[132:135], a[100:103], v[36:39]
    v_fma_f32 v67, v67, s35, v80
    v_cvt_pk_bf16_f32 v61, v62, v63
    v_mfma_f32_16x16x32_bf16 v[36:39], a[136:139], a[104:107], v[36:39]
    v_exp_f32 v67, v67
    v_mfma_f32_16x16x32_bf16 v[36:39], a[140:143], a[108:111], v[36:39]
    v_cvt_pk_bf16_f32 v62, v64, v65
    v_cvt_pk_bf16_f32 v63, v66, v67
    v_mfma_f32_16x16x32_bf16 v[40:43], a[144:147], a[96:99], 0
    v_mfma_f32_16x16x32_bf16 v[40:43], a[148:151], a[100:103], v[40:43]
    v_mfma_f32_16x16x32_bf16 v[40:43], a[152:155], a[104:107], v[40:43]
    v_mfma_f32_16x16x32_bf16 v[40:43], a[156:159], a[108:111], v[40:43]
    s_waitcnt vmcnt(0)
    s_barrier
    v_mfma_f32_16x16x32_bf16 v[44:47], a[128:131], a[112:115], 0
    ds_read_b128 a[128:131], v9 offset:40960
    s_add_u32 m0, s33, 32768
    v_mfma_f32_16x16x32_bf16 v[44:47], a[132:135], a[116:119], v[44:47]
    buffer_load_dwordx4 v2, s[16:19], s48 offen offset:0 nt lds
    v_fma_f32 v36, v36, s35, v84
    v_mfma_f32_16x16x32_bf16 v[44:47], a[136:139], a[120:123], v[44:47]
    ds_read_b128 a[132:135], v10 offset:40960
    v_fma_f32 v37, v37, s35, v84
    v_mfma_f32_16x16x32_bf16 v[44:47], a[140:143], a[124:127], v[44:47]
    v_exp_f32 v36, v36
    v_mfma_f32_16x16x32_bf16 v[48:51], a[144:147], a[112:115], 0
    v_exp_f32 v37, v37
    v_mfma_f32_16x16x32_bf16 v[48:51], a[148:151], a[116:119], v[48:51]
    ds_read_b128 a[136:139], v11 offset:40960
    buffer_load_dwordx4 v3, s[16:19], s48 offen offset:1024 nt lds
    v_mfma_f32_16x16x32_bf16 v[48:51], a[152:155], a[120:123], v[48:51]
    s_add_u32 m0, s34, 32768
    v_fma_f32 v38, v38, s35, v84
    v_mfma_f32_16x16x32_bf16 v[48:51], a[156:159], a[124:127], v[48:51]
    v_exp_f32 v38, v38
    v_mfma_f32_16x16x32_bf16 a[200:203], a[216:219], v[52:55], a[200:203]
    ds_read_b128 a[140:143], v12 offset:40960
    v_fma_f32 v39, v39, s35, v84
    v_mfma_f32_16x16x32_bf16 a[204:207], a[216:219], v[60:63], a[204:207]
    buffer_load_dwordx4 v4, s[20:23], s48 offen offset:0 nt lds
    v_fma_f32 v40, v40, s35, v84
    v_mfma_f32_16x16x32_bf16 v[128:131], a[160:163], v[52:55], v[128:131]
    ds_read_b128 a[144:147], v9 offset:45056
    v_fma_f32 v41, v41, s35, v84
    v_mfma_f32_16x16x32_bf16 v[160:163], a[160:163], v[60:63], v[160:163]
    v_exp_f32 v39, v39
    v_mfma_f32_16x16x32_bf16 v[164:167], a[164:167], v[60:63], v[164:167]
    v_exp_f32 v40, v40
    v_mfma_f32_16x16x32_bf16 v[132:135], a[164:167], v[52:55], v[132:135]
    ds_read_b128 a[148:151], v10 offset:45056
    buffer_load_dwordx4 v5, s[20:23], s48 offen offset:1024 nt lds
    v_mfma_f32_16x16x32_bf16 v[136:139], a[168:171], v[52:55], v[136:139]
    v_exp_f32 v41, v41
    v_mfma_f32_16x16x32_bf16 v[168:171], a[168:171], v[60:63], v[168:171]
    v_cvt_pk_bf16_f32 v36, v36, v37
    v_fma_f32 v42, v42, s35, v84
    v_mfma_f32_16x16x32_bf16 v[172:175], a[172:175], v[60:63], v[172:175]
    ds_read_b128 a[152:155], v11 offset:45056
    v_fma_f32 v43, v43, s35, v84
    v_mfma_f32_16x16x32_bf16 v[140:143], a[172:175], v[52:55], v[140:143]
    v_exp_f32 v42, v42
    v_mfma_f32_16x16x32_bf16 v[144:147], a[176:179], v[52:55], v[144:147]
    v_exp_f32 v43, v43
    v_mfma_f32_16x16x32_bf16 v[176:179], a[176:179], v[60:63], v[176:179]
    ds_read_b128 a[156:159], v12 offset:45056
    v_cvt_pk_bf16_f32 v37, v38, v39
    v_mfma_f32_16x16x32_bf16 v[180:183], a[180:183], v[60:63], v[180:183]
    v_cvt_pk_bf16_f32 v38, v40, v41
    v_cvt_pk_bf16_f32 v39, v42, v43
    v_mfma_f32_16x16x32_bf16 v[148:151], a[180:183], v[52:55], v[148:151]
    v_fma_f32 v44, v44, s35, v88
    v_fma_f32 v45, v45, s35, v88
    v_mfma_f32_16x16x32_bf16 v[152:155], a[184:187], v[52:55], v[152:155]
    v_exp_f32 v44, v44
    v_mfma_f32_16x16x32_bf16 v[184:187], a[184:187], v[60:63], v[184:187]
    v_exp_f32 v45, v45
    v_mfma_f32_16x16x32_bf16 v[188:191], a[188:191], v[60:63], v[188:191]
    v_fma_f32 v46, v46, s35, v88
    v_fma_f32 v47, v47, s35, v88
    v_mfma_f32_16x16x32_bf16 v[156:159], a[188:191], v[52:55], v[156:159]
    s_waitcnt lgkmcnt(0)
    v_fma_f32 v48, v48, s35, v88
    v_mfma_f32_16x16x32_bf16 v[52:55], a[128:131], a[32:35], v[68:71]
    v_exp_f32 v46, v46
    v_mfma_f32_16x16x32_bf16 v[52:55], a[132:135], a[36:39], v[52:55]
    v_exp_f32 v47, v47
    v_mfma_f32_16x16x32_bf16 v[52:55], a[136:139], a[40:43], v[52:55]
    v_exp_f32 v48, v48
    v_mfma_f32_16x16x32_bf16 v[52:55], a[140:143], a[44:47], v[52:55]
    v_fma_f32 v49, v49, s35, v88
    v_cvt_pk_bf16_f32 v44, v44, v45
    v_mfma_f32_16x16x32_bf16 v[56:59], a[144:147], a[32:35], v[68:71]
    v_exp_f32 v49, v49
    v_mfma_f32_16x16x32_bf16 v[56:59], a[148:151], a[36:39], v[56:59]
    v_fma_f32 v50, v50, s35, v88
    v_fma_f32 v51, v51, s35, v88
    v_mfma_f32_16x16x32_bf16 v[56:59], a[152:155], a[40:43], v[56:59]
    v_exp_f32 v50, v50
    v_mfma_f32_16x16x32_bf16 v[56:59], a[156:159], a[44:47], v[56:59]
    v_exp_f32 v51, v51
    v_mfma_f32_16x16x32_bf16 v[60:63], a[128:131], a[48:51], v[72:75]
    v_exp_f32 v52, v52
    v_mfma_f32_16x16x32_bf16 v[60:63], a[132:135], a[52:55], v[60:63]
    v_exp_f32 v53, v53
    v_mfma_f32_16x16x32_bf16 v[60:63], a[136:139], a[56:59], v[60:63]
    v_exp_f32 v54, v54
    v_mfma_f32_16x16x32_bf16 v[60:63], a[140:143], a[60:63], v[60:63]
    v_exp_f32 v55, v55
    v_mfma_f32_16x16x32_bf16 v[64:67], a[144:147], a[48:51], v[72:75]
    v_exp_f32 v56, v56
    v_mfma_f32_16x16x32_bf16 v[64:67], a[148:151], a[52:55], v[64:67]
    v_cvt_pk_bf16_f32 v45, v46, v47
    v_cvt_pk_bf16_f32 v46, v48, v49
    v_mfma_f32_16x16x32_bf16 v[64:67], a[152:155], a[56:59], v[64:67]
    v_cvt_pk_bf16_f32 v47, v50, v51
    v_cvt_pk_bf16_f32 v52, v52, v53
    v_mfma_f32_16x16x32_bf16 v[64:67], a[156:159], a[60:63], v[64:67]
    v_exp_f32 v57, v57
    v_mfma_f32_16x16x32_bf16 a[208:211], a[216:219], v[36:39], a[208:211]
    v_exp_f32 v58, v58
    v_mfma_f32_16x16x32_bf16 a[212:215], a[216:219], v[44:47], a[212:215]
    v_exp_f32 v59, v59
    v_mfma_f32_16x16x32_bf16 v[192:195], a[160:163], v[36:39], v[192:195]
    v_exp_f32 v60, v60
    v_mfma_f32_16x16x32_bf16 v[224:227], a[160:163], v[44:47], v[224:227]
    ds_read_b64_tr_b16 a[160:161], v13 offset:40960
    v_cvt_pk_bf16_f32 v53, v54, v55
    v_mfma_f32_16x16x32_bf16 v[228:231], a[164:167], v[44:47], v[228:231]
    ds_read_b64_tr_b16 a[162:163], v13 offset:45056
    v_cvt_pk_bf16_f32 v54, v56, v57
    v_mfma_f32_16x16x32_bf16 v[196:199], a[164:167], v[36:39], v[196:199]
    v_exp_f32 v61, v61
    v_mfma_f32_16x16x32_bf16 v[200:203], a[168:171], v[36:39], v[200:203]
    ds_read_b64_tr_b16 a[164:165], v14 offset:40960
    v_cvt_pk_bf16_f32 v55, v58, v59
    v_mfma_f32_16x16x32_bf16 v[232:235], a[168:171], v[44:47], v[232:235]
    v_exp_f32 v62, v62
    v_mfma_f32_16x16x32_bf16 v[236:239], a[172:175], v[44:47], v[236:239]
    ds_read_b64_tr_b16 a[166:167], v14 offset:45056
    v_cvt_pk_bf16_f32 v60, v60, v61
    v_mfma_f32_16x16x32_bf16 v[204:207], a[172:175], v[36:39], v[204:207]
    v_exp_f32 v63, v63
    v_mfma_f32_16x16x32_bf16 v[208:211], a[176:179], v[36:39], v[208:211]
    ds_read_b64_tr_b16 a[168:169], v15 offset:40960
    v_cvt_pk_bf16_f32 v61, v62, v63
    v_mfma_f32_16x16x32_bf16 v[240:243], a[176:179], v[44:47], v[240:243]
    v_exp_f32 v64, v64
    v_mfma_f32_16x16x32_bf16 v[244:247], a[180:183], v[44:47], v[244:247]
    ds_read_b64_tr_b16 a[170:171], v15 offset:45056
    s_add_u32 s48, s48, 16384
    v_mfma_f32_16x16x32_bf16 v[212:215], a[180:183], v[36:39], v[212:215]
    ds_read_b64_tr_b16 a[172:173], v16 offset:40960
    v_mfma_f32_16x16x32_bf16 v[216:219], a[184:187], v[36:39], v[216:219]
    v_exp_f32 v65, v65
    v_mfma_f32_16x16x32_bf16 v[248:251], a[184:187], v[44:47], v[248:251]
    ds_read_b64_tr_b16 a[174:175], v16 offset:45056
    v_cvt_pk_bf16_f32 v62, v64, v65
    v_mfma_f32_16x16x32_bf16 v[252:255], a[188:191], v[44:47], v[252:255]
    v_exp_f32 v66, v66
    v_mfma_f32_16x16x32_bf16 v[220:223], a[188:191], v[36:39], v[220:223]
    ds_read_b64_tr_b16 a[176:177], v17 offset:40960
    v_mfma_f32_16x16x32_bf16 v[36:39], a[128:131], a[64:67], 0
    v_exp_f32 v67, v67
    v_mfma_f32_16x16x32_bf16 v[36:39], a[132:135], a[68:71], v[36:39]
    ds_read_b64_tr_b16 a[178:179], v17 offset:45056
    v_cvt_pk_bf16_f32 v63, v66, v67
    v_mfma_f32_16x16x32_bf16 v[36:39], a[136:139], a[72:75], v[36:39]
    v_mfma_f32_16x16x32_bf16 v[36:39], a[140:143], a[76:79], v[36:39]
    ds_read_b64_tr_b16 a[180:181], v18 offset:40960
    v_mfma_f32_16x16x32_bf16 v[40:43], a[144:147], a[64:67], 0
    ds_read_b64_tr_b16 a[182:183], v18 offset:45056
    v_mfma_f32_16x16x32_bf16 v[40:43], a[148:151], a[68:71], v[40:43]
    v_mfma_f32_16x16x32_bf16 v[40:43], a[152:155], a[72:75], v[40:43]
    ds_read_b64_tr_b16 a[184:185], v19 offset:40960
    v_mfma_f32_16x16x32_bf16 v[40:43], a[156:159], a[76:79], v[40:43]
    v_mfma_f32_16x16x32_bf16 v[44:47], a[128:131], a[80:83], 0
    ds_read_b64_tr_b16 a[186:187], v19 offset:45056
    v_fma_f32 v36, v36, s35, v76
    v_mfma_f32_16x16x32_bf16 v[44:47], a[132:135], a[84:87], v[44:47]
    v_exp_f32 v36, v36
    v_mfma_f32_16x16x32_bf16 v[44:47], a[136:139], a[88:91], v[44:47]
    ds_read_b64_tr_b16 a[188:189], v20 offset:40960
    v_fma_f32 v37, v37, s35, v76
    v_mfma_f32_16x16x32_bf16 v[44:47], a[140:143], a[92:95], v[44:47]
    v_exp_f32 v37, v37
    v_mfma_f32_16x16x32_bf16 v[48:51], a[144:147], a[80:83], 0
    ds_read_b64_tr_b16 a[190:191], v20 offset:45056
    v_fma_f32 v38, v38, s35, v76
    v_mfma_f32_16x16x32_bf16 v[48:51], a[148:151], a[84:87], v[48:51]
    v_exp_f32 v38, v38
    v_mfma_f32_16x16x32_bf16 v[48:51], a[152:155], a[88:91], v[48:51]
    v_fma_f32 v39, v39, s35, v76
    v_fma_f32 v40, v40, s35, v76
    v_mfma_f32_16x16x32_bf16 v[48:51], a[156:159], a[92:95], v[48:51]
    v_exp_f32 v39, v39
    v_mfma_f32_16x16x32_bf16 a[192:195], a[216:219], v[52:55], a[192:195]
    v_exp_f32 v40, v40
    v_mfma_f32_16x16x32_bf16 a[196:199], a[216:219], v[60:63], a[196:199]
    s_waitcnt lgkmcnt(0)
    v_fma_f32 v41, v41, s35, v76
    v_mfma_f32_16x16x32_bf16 a[0:3], a[160:163], v[52:55], a[0:3]
    v_exp_f32 v41, v41
    v_mfma_f32_16x16x32_bf16 v[96:99], a[160:163], v[60:63], v[96:99]
    v_cvt_pk_bf16_f32 v36, v36, v37
    v_fma_f32 v42, v42, s35, v76
    v_mfma_f32_16x16x32_bf16 v[100:103], a[164:167], v[60:63], v[100:103]
    v_exp_f32 v42, v42
    v_mfma_f32_16x16x32_bf16 a[4:7], a[164:167], v[52:55], a[4:7]
    v_fma_f32 v43, v43, s35, v76
    v_cvt_pk_bf16_f32 v37, v38, v39
    v_mfma_f32_16x16x32_bf16 a[8:11], a[168:171], v[52:55], a[8:11]
    v_exp_f32 v43, v43
    v_mfma_f32_16x16x32_bf16 v[104:107], a[168:171], v[60:63], v[104:107]
    v_cvt_pk_bf16_f32 v38, v40, v41
    v_cvt_pk_bf16_f32 v39, v42, v43
    v_mfma_f32_16x16x32_bf16 v[108:111], a[172:175], v[60:63], v[108:111]
    v_fma_f32 v44, v44, s35, v80
    v_fma_f32 v45, v45, s35, v80
    v_mfma_f32_16x16x32_bf16 a[12:15], a[172:175], v[52:55], a[12:15]
    v_exp_f32 v44, v44
    v_mfma_f32_16x16x32_bf16 a[16:19], a[176:179], v[52:55], a[16:19]
    v_exp_f32 v45, v45
    v_mfma_f32_16x16x32_bf16 v[112:115], a[176:179], v[60:63], v[112:115]
    v_fma_f32 v46, v46, s35, v80
    v_fma_f32 v47, v47, s35, v80
    v_mfma_f32_16x16x32_bf16 v[116:119], a[180:183], v[60:63], v[116:119]
    v_exp_f32 v46, v46
    v_mfma_f32_16x16x32_bf16 a[20:23], a[180:183], v[52:55], a[20:23]
    v_exp_f32 v47, v47
    v_mfma_f32_16x16x32_bf16 a[24:27], a[184:187], v[52:55], a[24:27]
    v_fma_f32 v48, v48, s35, v80
    v_fma_f32 v49, v49, s35, v80
    v_mfma_f32_16x16x32_bf16 v[120:123], a[184:187], v[60:63], v[120:123]
    v_exp_f32 v48, v48
    v_mfma_f32_16x16x32_bf16 v[124:127], a[188:191], v[60:63], v[124:127]
    v_exp_f32 v49, v49
    v_mfma_f32_16x16x32_bf16 a[28:31], a[188:191], v[52:55], a[28:31]
    v_cvt_pk_bf16_f32 v44, v44, v45
    v_fma_f32 v50, v50, s35, v80
    v_mfma_f32_16x16x32_bf16 v[52:55], a[128:131], a[96:99], 0
    v_exp_f32 v50, v50
    v_mfma_f32_16x16x32_bf16 v[52:55], a[132:135], a[100:103], v[52:55]
    v_fma_f32 v51, v51, s35, v80
    v_cvt_pk_bf16_f32 v45, v46, v47
    v_mfma_f32_16x16x32_bf16 v[52:55], a[136:139], a[104:107], v[52:55]
    v_exp_f32 v51, v51
    v_mfma_f32_16x16x32_bf16 v[52:55], a[140:143], a[108:111], v[52:55]
    v_cvt_pk_bf16_f32 v46, v48, v49
    v_cvt_pk_bf16_f32 v47, v50, v51
    v_mfma_f32_16x16x32_bf16 v[56:59], a[144:147], a[96:99], 0
    v_mfma_f32_16x16x32_bf16 v[56:59], a[148:151], a[100:103], v[56:59]
    v_mfma_f32_16x16x32_bf16 v[56:59], a[152:155], a[104:107], v[56:59]
    v_mfma_f32_16x16x32_bf16 v[56:59], a[156:159], a[108:111], v[56:59]
    s_waitcnt vmcnt(0)
    s_barrier
    v_mfma_f32_16x16x32_bf16 v[60:63], a[128:131], a[112:115], 0
    ds_read_b128 a[128:131], v9 offset:32768
    s_add_u32 m0, s33, 40960
    v_mfma_f32_16x16x32_bf16 v[60:63], a[132:135], a[116:119], v[60:63]
    buffer_load_dwordx4 v2, s[16:19], s49 offen offset:0 nt lds
    v_fma_f32 v52, v52, s35, v84
    v_mfma_f32_16x16x32_bf16 v[60:63], a[136:139], a[120:123], v[60:63]
    ds_read_b128 a[132:135], v10 offset:32768
    v_fma_f32 v53, v53, s35, v84
    v_mfma_f32_16x16x32_bf16 v[60:63], a[140:143], a[124:127], v[60:63]
    v_exp_f32 v52, v52
    v_mfma_f32_16x16x32_bf16 v[64:67], a[144:147], a[112:115], 0
    v_exp_f32 v53, v53
    v_mfma_f32_16x16x32_bf16 v[64:67], a[148:151], a[116:119], v[64:67]
    ds_read_b128 a[136:139], v11 offset:32768
    buffer_load_dwordx4 v3, s[16:19], s49 offen offset:1024 nt lds
    v_mfma_f32_16x16x32_bf16 v[64:67], a[152:155], a[120:123], v[64:67]
    s_add_u32 m0, s34, 40960
    v_fma_f32 v54, v54, s35, v84
    v_mfma_f32_16x16x32_bf16 v[64:67], a[156:159], a[124:127], v[64:67]
    v_exp_f32 v54, v54
    v_mfma_f32_16x16x32_bf16 a[200:203], a[216:219], v[36:39], a[200:203]
    ds_read_b128 a[140:143], v12 offset:32768
    v_fma_f32 v55, v55, s35, v84
    v_mfma_f32_16x16x32_bf16 a[204:207], a[216:219], v[44:47], a[204:207]
    buffer_load_dwordx4 v4, s[20:23], s49 offen offset:0 nt lds
    v_fma_f32 v56, v56, s35, v84
    v_mfma_f32_16x16x32_bf16 v[128:131], a[160:163], v[36:39], v[128:131]
    ds_read_b128 a[144:147], v9 offset:36864
    v_fma_f32 v57, v57, s35, v84
    v_mfma_f32_16x16x32_bf16 v[160:163], a[160:163], v[44:47], v[160:163]
    v_exp_f32 v55, v55
    v_mfma_f32_16x16x32_bf16 v[164:167], a[164:167], v[44:47], v[164:167]
    v_exp_f32 v56, v56
    v_mfma_f32_16x16x32_bf16 v[132:135], a[164:167], v[36:39], v[132:135]
    ds_read_b128 a[148:151], v10 offset:36864
    buffer_load_dwordx4 v5, s[20:23], s49 offen offset:1024 nt lds
    v_mfma_f32_16x16x32_bf16 v[136:139], a[168:171], v[36:39], v[136:139]
    v_exp_f32 v57, v57
    v_mfma_f32_16x16x32_bf16 v[168:171], a[168:171], v[44:47], v[168:171]
    v_cvt_pk_bf16_f32 v52, v52, v53
    v_fma_f32 v58, v58, s35, v84
    v_mfma_f32_16x16x32_bf16 v[172:175], a[172:175], v[44:47], v[172:175]
    ds_read_b128 a[152:155], v11 offset:36864
    v_fma_f32 v59, v59, s35, v84
    v_mfma_f32_16x16x32_bf16 v[140:143], a[172:175], v[36:39], v[140:143]
    v_exp_f32 v58, v58
    v_mfma_f32_16x16x32_bf16 v[144:147], a[176:179], v[36:39], v[144:147]
    v_exp_f32 v59, v59
    v_mfma_f32_16x16x32_bf16 v[176:179], a[176:179], v[44:47], v[176:179]
    ds_read_b128 a[156:159], v12 offset:36864
    v_cvt_pk_bf16_f32 v53, v54, v55
    v_mfma_f32_16x16x32_bf16 v[180:183], a[180:183], v[44:47], v[180:183]
    v_cvt_pk_bf16_f32 v54, v56, v57
    v_cvt_pk_bf16_f32 v55, v58, v59
    v_mfma_f32_16x16x32_bf16 v[148:151], a[180:183], v[36:39], v[148:151]
    v_fma_f32 v60, v60, s35, v88
    v_fma_f32 v61, v61, s35, v88
    v_mfma_f32_16x16x32_bf16 v[152:155], a[184:187], v[36:39], v[152:155]
    v_exp_f32 v60, v60
    v_mfma_f32_16x16x32_bf16 v[184:187], a[184:187], v[44:47], v[184:187]
    v_exp_f32 v61, v61
    v_mfma_f32_16x16x32_bf16 v[188:191], a[188:191], v[44:47], v[188:191]
    v_fma_f32 v62, v62, s35, v88
    v_fma_f32 v63, v63, s35, v88
    v_mfma_f32_16x16x32_bf16 v[156:159], a[188:191], v[36:39], v[156:159]
    s_waitcnt lgkmcnt(0)
    v_fma_f32 v64, v64, s35, v88
    v_mfma_f32_16x16x32_bf16 v[36:39], a[128:131], a[32:35], v[68:71]
    v_exp_f32 v62, v62
    v_mfma_f32_16x16x32_bf16 v[36:39], a[132:135], a[36:39], v[36:39]
    v_exp_f32 v63, v63
    v_mfma_f32_16x16x32_bf16 v[36:39], a[136:139], a[40:43], v[36:39]
    v_exp_f32 v64, v64
    v_mfma_f32_16x16x32_bf16 v[36:39], a[140:143], a[44:47], v[36:39]
    v_fma_f32 v65, v65, s35, v88
    v_cvt_pk_bf16_f32 v60, v60, v61
    v_mfma_f32_16x16x32_bf16 v[40:43], a[144:147], a[32:35], v[68:71]
    v_exp_f32 v65, v65
    v_mfma_f32_16x16x32_bf16 v[40:43], a[148:151], a[36:39], v[40:43]
    v_fma_f32 v66, v66, s35, v88
    v_fma_f32 v67, v67, s35, v88
    v_mfma_f32_16x16x32_bf16 v[40:43], a[152:155], a[40:43], v[40:43]
    v_exp_f32 v66, v66
    v_mfma_f32_16x16x32_bf16 v[40:43], a[156:159], a[44:47], v[40:43]
    v_exp_f32 v67, v67
    v_mfma_f32_16x16x32_bf16 v[44:47], a[128:131], a[48:51], v[72:75]
    v_exp_f32 v36, v36
    v_mfma_f32_16x16x32_bf16 v[44:47], a[132:135], a[52:55], v[44:47]
    v_exp_f32 v37, v37
    v_mfma_f32_16x16x32_bf16 v[44:47], a[136:139], a[56:59], v[44:47]
    v_exp_f32 v38, v38
    v_mfma_f32_16x16x32_bf16 v[44:47], a[140:143], a[60:63], v[44:47]
    v_exp_f32 v39, v39
    v_mfma_f32_16x16x32_bf16 v[48:51], a[144:147], a[48:51], v[72:75]
    v_exp_f32 v40, v40
    v_mfma_f32_16x16x32_bf16 v[48:51], a[148:151], a[52:55], v[48:51]
    v_cvt_pk_bf16_f32 v61, v62, v63
    v_cvt_pk_bf16_f32 v62, v64, v65
    v_mfma_f32_16x16x32_bf16 v[48:51], a[152:155], a[56:59], v[48:51]
    v_cvt_pk_bf16_f32 v63, v66, v67
    v_cvt_pk_bf16_f32 v36, v36, v37
    v_mfma_f32_16x16x32_bf16 v[48:51], a[156:159], a[60:63], v[48:51]
    v_exp_f32 v41, v41
    v_mfma_f32_16x16x32_bf16 a[208:211], a[216:219], v[52:55], a[208:211]
    v_exp_f32 v42, v42
    v_mfma_f32_16x16x32_bf16 a[212:215], a[216:219], v[60:63], a[212:215]
    v_exp_f32 v43, v43
    v_mfma_f32_16x16x32_bf16 v[192:195], a[160:163], v[52:55], v[192:195]
    v_exp_f32 v44, v44
    v_mfma_f32_16x16x32_bf16 v[224:227], a[160:163], v[60:63], v[224:227]
    ds_read_b64_tr_b16 a[160:161], v13 offset:32768
    v_cvt_pk_bf16_f32 v37, v38, v39
    v_mfma_f32_16x16x32_bf16 v[228:231], a[164:167], v[60:63], v[228:231]
    ds_read_b64_tr_b16 a[162:163], v13 offset:36864
    v_cvt_pk_bf16_f32 v38, v40, v41
    v_mfma_f32_16x16x32_bf16 v[196:199], a[164:167], v[52:55], v[196:199]
    v_exp_f32 v45, v45
    v_mfma_f32_16x16x32_bf16 v[200:203], a[168:171], v[52:55], v[200:203]
    ds_read_b64_tr_b16 a[164:165], v14 offset:32768
    v_cvt_pk_bf16_f32 v39, v42, v43
    v_mfma_f32_16x16x32_bf16 v[232:235], a[168:171], v[60:63], v[232:235]
    v_exp_f32 v46, v46
    v_mfma_f32_16x16x32_bf16 v[236:239], a[172:175], v[60:63], v[236:239]
    ds_read_b64_tr_b16 a[166:167], v14 offset:36864
    v_cvt_pk_bf16_f32 v44, v44, v45
    v_mfma_f32_16x16x32_bf16 v[204:207], a[172:175], v[52:55], v[204:207]
    v_exp_f32 v47, v47
    v_mfma_f32_16x16x32_bf16 v[208:211], a[176:179], v[52:55], v[208:211]
    ds_read_b64_tr_b16 a[168:169], v15 offset:32768
    v_cvt_pk_bf16_f32 v45, v46, v47
    v_mfma_f32_16x16x32_bf16 v[240:243], a[176:179], v[60:63], v[240:243]
    v_exp_f32 v48, v48
    v_mfma_f32_16x16x32_bf16 v[244:247], a[180:183], v[60:63], v[244:247]
    ds_read_b64_tr_b16 a[170:171], v15 offset:36864
    s_add_u32 s49, s49, 16384
    v_mfma_f32_16x16x32_bf16 v[212:215], a[180:183], v[52:55], v[212:215]
    ds_read_b64_tr_b16 a[172:173], v16 offset:32768
    v_mfma_f32_16x16x32_bf16 v[216:219], a[184:187], v[52:55], v[216:219]
    v_exp_f32 v49, v49
    v_mfma_f32_16x16x32_bf16 v[248:251], a[184:187], v[60:63], v[248:251]
    ds_read_b64_tr_b16 a[174:175], v16 offset:36864
    v_cvt_pk_bf16_f32 v46, v48, v49
    v_mfma_f32_16x16x32_bf16 v[252:255], a[188:191], v[60:63], v[252:255]
    v_exp_f32 v50, v50
    v_mfma_f32_16x16x32_bf16 v[220:223], a[188:191], v[52:55], v[220:223]
    ds_read_b64_tr_b16 a[176:177], v17 offset:32768
    v_mfma_f32_16x16x32_bf16 v[52:55], a[128:131], a[64:67], 0
    v_exp_f32 v51, v51
    v_mfma_f32_16x16x32_bf16 v[52:55], a[132:135], a[68:71], v[52:55]
    ds_read_b64_tr_b16 a[178:179], v17 offset:36864
    v_cvt_pk_bf16_f32 v47, v50, v51
    v_mfma_f32_16x16x32_bf16 v[52:55], a[136:139], a[72:75], v[52:55]
    s_cmp_lg_u32 s48, 131072
    s_cbranch_scc1 Lsteady
Lpost:
    v_mfma_f32_16x16x32_bf16 v[52:55], a[140:143], a[76:79], v[52:55]
    ds_read_b64_tr_b16 a[180:181], v18 offset:32768
    v_mfma_f32_16x16x32_bf16 v[56:59], a[144:147], a[64:67], 0
    ds_read_b64_tr_b16 a[182:183], v18 offset:36864
    v_mfma_f32_16x16x32_bf16 v[56:59], a[148:151], a[68:71], v[56:59]
    v_mfma_f32_16x16x32_bf16 v[56:59], a[152:155], a[72:75], v[56:59]
    ds_read_b64_tr_b16 a[184:185], v19 offset:32768
    v_mfma_f32_16x16x32_bf16 v[56:59], a[156:159], a[76:79], v[56:59]
    v_mfma_f32_16x16x32_bf16 v[60:63], a[128:131], a[80:83], 0
    ds_read_b64_tr_b16 a[186:187], v19 offset:36864
    v_fma_f32 v52, v52, s35, v76
    v_mfma_f32_16x16x32_bf16 v[60:63], a[132:135], a[84:87], v[60:63]
    v_exp_f32 v52, v52
    v_mfma_f32_16x16x32_bf16 v[60:63], a[136:139], a[88:91], v[60:63]
    ds_read_b64_tr_b16 a[188:189], v20 offset:32768
    v_fma_f32 v53, v53, s35, v76
    v_mfma_f32_16x16x32_bf16 v[60:63], a[140:143], a[92:95], v[60:63]
    v_exp_f32 v53, v53
    v_mfma_f32_16x16x32_bf16 v[64:67], a[144:147], a[80:83], 0
    ds_read_b64_tr_b16 a[190:191], v20 offset:36864
    v_fma_f32 v54, v54, s35, v76
    v_mfma_f32_16x16x32_bf16 v[64:67], a[148:151], a[84:87], v[64:67]
    v_exp_f32 v54, v54
    v_mfma_f32_16x16x32_bf16 v[64:67], a[152:155], a[88:91], v[64:67]
    v_fma_f32 v55, v55, s35, v76
    v_fma_f32 v56, v56, s35, v76
    v_mfma_f32_16x16x32_bf16 v[64:67], a[156:159], a[92:95], v[64:67]
    v_exp_f32 v55, v55
    v_mfma_f32_16x16x32_bf16 a[192:195], a[216:219], v[36:39], a[192:195]
    v_exp_f32 v56, v56
    v_mfma_f32_16x16x32_bf16 a[196:199], a[216:219], v[44:47], a[196:199]
    s_waitcnt lgkmcnt(0)
    v_fma_f32 v57, v57, s35, v76
    v_mfma_f32_16x16x32_bf16 a[0:3], a[160:163], v[36:39], a[0:3]
    v_exp_f32 v57, v57
    v_mfma_f32_16x16x32_bf16 v[96:99], a[160:163], v[44:47], v[96:99]
    v_cvt_pk_bf16_f32 v52, v52, v53
    v_fma_f32 v58, v58, s35, v76
    v_mfma_f32_16x16x32_bf16 v[100:103], a[164:167], v[44:47], v[100:103]
    v_exp_f32 v58, v58
    v_mfma_f32_16x16x32_bf16 a[4:7], a[164:167], v[36:39], a[4:7]
    v_fma_f32 v59, v59, s35, v76
    v_cvt_pk_bf16_f32 v53, v54, v55
    v_mfma_f32_16x16x32_bf16 a[8:11], a[168:171], v[36:39], a[8:11]
    v_exp_f32 v59, v59
    v_mfma_f32_16x16x32_bf16 v[104:107], a[168:171], v[44:47], v[104:107]
    v_cvt_pk_bf16_f32 v54, v56, v57
    v_cvt_pk_bf16_f32 v55, v58, v59
    v_mfma_f32_16x16x32_bf16 v[108:111], a[172:175], v[44:47], v[108:111]
    v_fma_f32 v60, v60, s35, v80
    v_fma_f32 v61, v61, s35, v80
    v_mfma_f32_16x16x32_bf16 a[12:15], a[172:175], v[36:39], a[12:15]
    v_exp_f32 v60, v60
    v_mfma_f32_16x16x32_bf16 a[16:19], a[176:179], v[36:39], a[16:19]
    v_exp_f32 v61, v61
    v_mfma_f32_16x16x32_bf16 v[112:115], a[176:179], v[44:47], v[112:115]
    v_fma_f32 v62, v62, s35, v80
    v_fma_f32 v63, v63, s35, v80
    v_mfma_f32_16x16x32_bf16 v[116:119], a[180:183], v[44:47], v[116:119]
    v_exp_f32 v62, v62
    v_mfma_f32_16x16x32_bf16 a[20:23], a[180:183], v[36:39], a[20:23]
    v_exp_f32 v63, v63
    v_mfma_f32_16x16x32_bf16 a[24:27], a[184:187], v[36:39], a[24:27]
    v_fma_f32 v64, v64, s35, v80
    v_fma_f32 v65, v65, s35, v80
    v_mfma_f32_16x16x32_bf16 v[120:123], a[184:187], v[44:47], v[120:123]
    v_exp_f32 v64, v64
    v_mfma_f32_16x16x32_bf16 v[124:127], a[188:191], v[44:47], v[124:127]
    v_exp_f32 v65, v65
    v_mfma_f32_16x16x32_bf16 a[28:31], a[188:191], v[36:39], a[28:31]
    v_cvt_pk_bf16_f32 v60, v60, v61
    v_fma_f32 v66, v66, s35, v80
    v_mfma_f32_16x16x32_bf16 v[36:39], a[128:131], a[96:99], 0
    v_exp_f32 v66, v66
    v_mfma_f32_16x16x32_bf16 v[36:39], a[132:135], a[100:103], v[36:39]
    v_fma_f32 v67, v67, s35, v80
    v_cvt_pk_bf16_f32 v61, v62, v63
    v_mfma_f32_16x16x32_bf16 v[36:39], a[136:139], a[104:107], v[36:39]
    v_exp_f32 v67, v67
    v_mfma_f32_16x16x32_bf16 v[36:39], a[140:143], a[108:111], v[36:39]
    v_cvt_pk_bf16_f32 v62, v64, v65
    v_cvt_pk_bf16_f32 v63, v66, v67
    v_mfma_f32_16x16x32_bf16 v[40:43], a[144:147], a[96:99], 0
    v_mfma_f32_16x16x32_bf16 v[40:43], a[148:151], a[100:103], v[40:43]
    v_mfma_f32_16x16x32_bf16 v[40:43], a[152:155], a[104:107], v[40:43]
    v_mfma_f32_16x16x32_bf16 v[40:43], a[156:159], a[108:111], v[40:43]
    s_waitcnt vmcnt(0)
    s_barrier
    v_mfma_f32_16x16x32_bf16 v[44:47], a[128:131], a[112:115], 0
    ds_read_b128 a[128:131], v9 offset:40960
    v_fma_f32 v36, v36, s35, v84
    v_mfma_f32_16x16x32_bf16 v[44:47], a[132:135], a[116:119], v[44:47]
    v_exp_f32 v36, v36
    v_mfma_f32_16x16x32_bf16 v[44:47], a[136:139], a[120:123], v[44:47]
    ds_read_b128 a[132:135], v10 offset:40960
    v_fma_f32 v37, v37, s35, v84
    v_mfma_f32_16x16x32_bf16 v[44:47], a[140:143], a[124:127], v[44:47]
    v_exp_f32 v37, v37
    v_mfma_f32_16x16x32_bf16 v[48:51], a[144:147], a[112:115], 0
    v_fma_f32 v38, v38, s35, v84
    v_fma_f32 v39, v39, s35, v84
    v_mfma_f32_16x16x32_bf16 v[48:51], a[148:151], a[116:119], v[48:51]
    ds_read_b128 a[136:139], v11 offset:40960
    v_fma_f32 v40, v40, s35, v84
    v_mfma_f32_16x16x32_bf16 v[48:51], a[152:155], a[120:123], v[48:51]
    v_exp_f32 v38, v38
    v_mfma_f32_16x16x32_bf16 v[48:51], a[156:159], a[124:127], v[48:51]
    v_exp_f32 v39, v39
    v_mfma_f32_16x16x32_bf16 a[200:203], a[216:219], v[52:55], a[200:203]
    ds_read_b128 a[140:143], v12 offset:40960
    v_fma_f32 v41, v41, s35, v84
    v_mfma_f32_16x16x32_bf16 a[204:207], a[216:219], v[60:63], a[204:207]
    v_exp_f32 v40, v40
    v_mfma_f32_16x16x32_bf16 v[128:131], a[160:163], v[52:55], v[128:131]
    ds_read_b128 a[144:147], v9 offset:45056
    v_cvt_pk_bf16_f32 v36, v36, v37
    v_mfma_f32_16x16x32_bf16 v[160:163], a[160:163], v[60:63], v[160:163]
    v_exp_f32 v41, v41
    v_mfma_f32_16x16x32_bf16 v[164:167], a[164:167], v[60:63], v[164:167]
    v_fma_f32 v42, v42, s35, v84
    v_fma_f32 v43, v43, s35, v84
    v_mfma_f32_16x16x32_bf16 v[132:135], a[164:167], v[52:55], v[132:135]
    ds_read_b128 a[148:151], v10 offset:45056
    v_cvt_pk_bf16_f32 v37, v38, v39
    v_mfma_f32_16x16x32_bf16 v[136:139], a[168:171], v[52:55], v[136:139]
    v_exp_f32 v42, v42
    v_mfma_f32_16x16x32_bf16 v[168:171], a[168:171], v[60:63], v[168:171]
    v_exp_f32 v43, v43
    v_mfma_f32_16x16x32_bf16 v[172:175], a[172:175], v[60:63], v[172:175]
    ds_read_b128 a[152:155], v11 offset:45056
    v_cvt_pk_bf16_f32 v38, v40, v41
    v_mfma_f32_16x16x32_bf16 v[140:143], a[172:175], v[52:55], v[140:143]
    v_cvt_pk_bf16_f32 v39, v42, v43
    v_fma_f32 v44, v44, s35, v88
    v_mfma_f32_16x16x32_bf16 v[144:147], a[176:179], v[52:55], v[144:147]
    v_exp_f32 v44, v44
    v_mfma_f32_16x16x32_bf16 v[176:179], a[176:179], v[60:63], v[176:179]
    ds_read_b128 a[156:159], v12 offset:45056
    v_fma_f32 v45, v45, s35, v88
    v_mfma_f32_16x16x32_bf16 v[180:183], a[180:183], v[60:63], v[180:183]
    v_exp_f32 v45, v45
    v_mfma_f32_16x16x32_bf16 v[148:151], a[180:183], v[52:55], v[148:151]
    v_fma_f32 v46, v46, s35, v88
    v_fma_f32 v47, v47, s35, v88
    v_mfma_f32_16x16x32_bf16 v[152:155], a[184:187], v[52:55], v[152:155]
    v_exp_f32 v46, v46
    v_mfma_f32_16x16x32_bf16 v[184:187], a[184:187], v[60:63], v[184:187]
    v_exp_f32 v47, v47
    v_mfma_f32_16x16x32_bf16 v[188:191], a[188:191], v[60:63], v[188:191]
    v_fma_f32 v48, v48, s35, v88
    v_fma_f32 v49, v49, s35, v88
    v_mfma_f32_16x16x32_bf16 v[156:159], a[188:191], v[52:55], v[156:159]
    s_waitcnt lgkmcnt(0)
    v_cvt_pk_bf16_f32 v44, v44, v45
    v_mfma_f32_16x16x32_bf16 v[52:55], a[128:131], a[32:35], v[68:71]
    v_exp_f32 v48, v48
    v_mfma_f32_16x16x32_bf16 v[52:55], a[132:135], a[36:39], v[52:55]
    v_exp_f32 v49, v49
    v_mfma_f32_16x16x32_bf16 v[52:55], a[136:139], a[40:43], v[52:55]
    v_fma_f32 v50, v50, s35, v88
    v_fma_f32 v51, v51, s35, v88
    v_mfma_f32_16x16x32_bf16 v[52:55], a[140:143], a[44:47], v[52:55]
    v_exp_f32 v50, v50
    v_mfma_f32_16x16x32_bf16 v[56:59], a[144:147], a[32:35], v[68:71]
    v_exp_f32 v51, v51
    v_mfma_f32_16x16x32_bf16 v[56:59], a[148:151], a[36:39], v[56:59]
    v_cvt_pk_bf16_f32 v45, v46, v47
    v_cvt_pk_bf16_f32 v46, v48, v49
    v_mfma_f32_16x16x32_bf16 v[56:59], a[152:155], a[40:43], v[56:59]
    v_cvt_pk_bf16_f32 v47, v50, v51
    v_mfma_f32_16x16x32_bf16 v[56:59], a[156:159], a[44:47], v[56:59]
    v_exp_f32 v52, v52
    v_mfma_f32_16x16x32_bf16 v[60:63], a[128:131], a[48:51], v[72:75]
    v_exp_f32 v53, v53
    v_mfma_f32_16x16x32_bf16 v[60:63], a[132:135], a[52:55], v[60:63]
    v_exp_f32 v54, v54
    v_mfma_f32_16x16x32_bf16 v[60:63], a[136:139], a[56:59], v[60:63]
    v_exp_f32 v55, v55
    v_mfma_f32_16x16x32_bf16 v[60:63], a[140:143], a[60:63], v[60:63]
    v_exp_f32 v56, v56
    v_mfma_f32_16x16x32_bf16 v[64:67], a[144:147], a[48:51], v[72:75]
    v_exp_f32 v57, v57
    v_mfma_f32_16x16x32_bf16 v[64:67], a[148:151], a[52:55], v[64:67]
    v_exp_f32 v58, v58
    v_mfma_f32_16x16x32_bf16 v[64:67], a[152:155], a[56:59], v[64:67]
    v_exp_f32 v59, v59
    v_mfma_f32_16x16x32_bf16 v[64:67], a[156:159], a[60:63], v[64:67]
    v_exp_f32 v60, v60
    v_mfma_f32_16x16x32_bf16 a[208:211], a[216:219], v[36:39], a[208:211]
    v_exp_f32 v61, v61
    v_mfma_f32_16x16x32_bf16 a[212:215], a[216:219], v[44:47], a[212:215]
    v_exp_f32 v62, v62
    v_mfma_f32_16x16x32_bf16 v[192:195], a[160:163], v[36:39], v[192:195]
    v_exp_f32 v63, v63
    v_mfma_f32_16x16x32_bf16 v[224:227], a[160:163], v[44:47], v[224:227]
    ds_read_b64_tr_b16 a[160:161], v13 offset:40960
    v_cvt_pk_bf16_f32 v52, v52, v53
    v_mfma_f32_16x16x32_bf16 v[228:231], a[164:167], v[44:47], v[228:231]
    ds_read_b64_tr_b16 a[162:163], v13 offset:45056
    v_cvt_pk_bf16_f32 v53, v54, v55
    v_mfma_f32_16x16x32_bf16 v[196:199], a[164:167], v[36:39], v[196:199]
    v_exp_f32 v64, v64
    v_mfma_f32_16x16x32_bf16 v[200:203], a[168:171], v[36:39], v[200:203]
    ds_read_b64_tr_b16 a[164:165], v14 offset:40960
    v_cvt_pk_bf16_f32 v54, v56, v57
    v_mfma_f32_16x16x32_bf16 v[232:235], a[168:171], v[44:47], v[232:235]
    v_exp_f32 v65, v65
    v_mfma_f32_16x16x32_bf16 v[236:239], a[172:175], v[44:47], v[236:239]
    ds_read_b64_tr_b16 a[166:167], v14 offset:45056
    v_cvt_pk_bf16_f32 v55, v58, v59
    v_mfma_f32_16x16x32_bf16 v[204:207], a[172:175], v[36:39], v[204:207]
    v_exp_f32 v66, v66
    v_mfma_f32_16x16x32_bf16 v[208:211], a[176:179], v[36:39], v[208:211]
    ds_read_b64_tr_b16 a[168:169], v15 offset:40960
    v_cvt_pk_bf16_f32 v60, v60, v61
    v_mfma_f32_16x16x32_bf16 v[240:243], a[176:179], v[44:47], v[240:243]
    v_exp_f32 v67, v67
    v_mfma_f32_16x16x32_bf16 v[244:247], a[180:183], v[44:47], v[244:247]
    ds_read_b64_tr_b16 a[170:171], v15 offset:45056
    v_cvt_pk_bf16_f32 v61, v62, v63
    v_mfma_f32_16x16x32_bf16 v[212:215], a[180:183], v[36:39], v[212:215]
    ds_read_b64_tr_b16 a[172:173], v16 offset:40960
    v_cvt_pk_bf16_f32 v62, v64, v65
    v_mfma_f32_16x16x32_bf16 v[216:219], a[184:187], v[36:39], v[216:219]
    v_cvt_pk_bf16_f32 v63, v66, v67
    v_mfma_f32_16x16x32_bf16 v[248:251], a[184:187], v[44:47], v[248:251]
    ds_read_b64_tr_b16 a[174:175], v16 offset:45056
    v_mfma_f32_16x16x32_bf16 v[252:255], a[188:191], v[44:47], v[252:255]
    v_mfma_f32_16x16x32_bf16 v[220:223], a[188:191], v[36:39], v[220:223]
    ds_read_b64_tr_b16 a[176:177], v17 offset:40960
    v_mfma_f32_16x16x32_bf16 v[36:39], a[128:131], a[64:67], 0
    v_mfma_f32_16x16x32_bf16 v[36:39], a[132:135], a[68:71], v[36:39]
    ds_read_b64_tr_b16 a[178:179], v17 offset:45056
    v_mfma_f32_16x16x32_bf16 v[36:39], a[136:139], a[72:75], v[36:39]
    v_mfma_f32_16x16x32_bf16 v[36:39], a[140:143], a[76:79], v[36:39]
    ds_read_b64_tr_b16 a[180:181], v18 offset:40960
    v_mfma_f32_16x16x32_bf16 v[40:43], a[144:147], a[64:67], 0
    ds_read_b64_tr_b16 a[182:183], v18 offset:45056
    v_mfma_f32_16x16x32_bf16 v[40:43], a[148:151], a[68:71], v[40:43]
    v_mfma_f32_16x16x32_bf16 v[40:43], a[152:155], a[72:75], v[40:43]
    ds_read_b64_tr_b16 a[184:185], v19 offset:40960
    v_mfma_f32_16x16x32_bf16 v[40:43], a[156:159], a[76:79], v[40:43]
    v_mfma_f32_16x16x32_bf16 v[44:47], a[128:131], a[80:83], 0
    ds_read_b64_tr_b16 a[186:187], v19 offset:45056
    v_fma_f32 v36, v36, s35, v76
    v_mfma_f32_16x16x32_bf16 v[44:47], a[132:135], a[84:87], v[44:47]
    v_exp_f32 v36, v36
    v_mfma_f32_16x16x32_bf16 v[44:47], a[136:139], a[88:91], v[44:47]
    ds_read_b64_tr_b16 a[188:189], v20 offset:40960
    v_fma_f32 v37, v37, s35, v76
    v_mfma_f32_16x16x32_bf16 v[44:47], a[140:143], a[92:95], v[44:47]
    v_exp_f32 v37, v37
    v_mfma_f32_16x16x32_bf16 v[48:51], a[144:147], a[80:83], 0
    ds_read_b64_tr_b16 a[190:191], v20 offset:45056
    v_fma_f32 v38, v38, s35, v76
    v_mfma_f32_16x16x32_bf16 v[48:51], a[148:151], a[84:87], v[48:51]
    v_exp_f32 v38, v38
    v_mfma_f32_16x16x32_bf16 v[48:51], a[152:155], a[88:91], v[48:51]
    v_fma_f32 v39, v39, s35, v76
    v_fma_f32 v40, v40, s35, v76
    v_mfma_f32_16x16x32_bf16 v[48:51], a[156:159], a[92:95], v[48:51]
    v_exp_f32 v39, v39
    v_mfma_f32_16x16x32_bf16 a[192:195], a[216:219], v[52:55], a[192:195]
    v_exp_f32 v40, v40
    v_mfma_f32_16x16x32_bf16 a[196:199], a[216:219], v[60:63], a[196:199]
    s_waitcnt lgkmcnt(0)
    v_fma_f32 v41, v41, s35, v76
    v_mfma_f32_16x16x32_bf16 a[0:3], a[160:163], v[52:55], a[0:3]
    v_exp_f32 v41, v41
    v_mfma_f32_16x16x32_bf16 v[96:99], a[160:163], v[60:63], v[96:99]
    v_cvt_pk_bf16_f32 v36, v36, v37
    v_accvgpr_read_b32 v70, a192
    v_mfma_f32_16x16x32_bf16 v[100:103], a[164:167], v[60:63], v[100:103]
    v_rcp_f32 v69, v70
    v_mfma_f32_16x16x32_bf16 a[4:7], a[164:167], v[52:55], a[4:7]
    v_accvgpr_read_b32 v74, a196
    v_cmp_nge_f32 s[62:63], s3, v70
    v_mfma_f32_16x16x32_bf16 a[8:11], a[168:171], v[52:55], a[8:11]
    v_rcp_f32 v73, v74
    v_mfma_f32_16x16x32_bf16 v[104:107], a[168:171], v[60:63], v[104:107]
    v_cmp_nge_f32 s[64:65], s3, v74
    v_fma_f32 v42, v42, s35, v76
    v_mfma_f32_16x16x32_bf16 v[108:111], a[172:175], v[60:63], v[108:111]
    v_exp_f32 v42, v42
    v_mfma_f32_16x16x32_bf16 a[12:15], a[172:175], v[52:55], a[12:15]
    v_fma_f32 v43, v43, s35, v76
    v_cvt_pk_bf16_f32 v37, v38, v39
    v_mfma_f32_16x16x32_bf16 a[16:19], a[176:179], v[52:55], a[16:19]
    v_exp_f32 v43, v43
    v_mfma_f32_16x16x32_bf16 v[112:115], a[176:179], v[60:63], v[112:115]
    v_cvt_pk_bf16_f32 v38, v40, v41
    v_cvt_pk_bf16_f32 v39, v42, v43
    v_mfma_f32_16x16x32_bf16 v[116:119], a[180:183], v[60:63], v[116:119]
    v_fma_f32 v44, v44, s35, v80
    v_fma_f32 v45, v45, s35, v80
    v_mfma_f32_16x16x32_bf16 a[20:23], a[180:183], v[52:55], a[20:23]
    v_exp_f32 v44, v44
    v_mfma_f32_16x16x32_bf16 a[24:27], a[184:187], v[52:55], a[24:27]
    v_exp_f32 v45, v45
    v_mfma_f32_16x16x32_bf16 v[120:123], a[184:187], v[60:63], v[120:123]
    v_fma_f32 v46, v46, s35, v80
    v_fma_f32 v47, v47, s35, v80
    v_mfma_f32_16x16x32_bf16 v[124:127], a[188:191], v[60:63], v[124:127]
    v_exp_f32 v46, v46
    v_mfma_f32_16x16x32_bf16 a[28:31], a[188:191], v[52:55], a[28:31]
    v_exp_f32 v47, v47
    v_mfma_f32_16x16x32_bf16 v[52:55], a[128:131], a[96:99], 0
    v_fma_f32 v48, v48, s35, v80
    v_fma_f32 v49, v49, s35, v80
    v_mfma_f32_16x16x32_bf16 v[52:55], a[132:135], a[100:103], v[52:55]
    v_exp_f32 v48, v48
    v_mfma_f32_16x16x32_bf16 v[52:55], a[136:139], a[104:107], v[52:55]
    v_exp_f32 v49, v49
    v_mfma_f32_16x16x32_bf16 v[52:55], a[140:143], a[108:111], v[52:55]
    v_cvt_pk_bf16_f32 v44, v44, v45
    v_fma_f32 v50, v50, s35, v80
    v_mfma_f32_16x16x32_bf16 v[56:59], a[144:147], a[96:99], 0
    v_exp_f32 v50, v50
    v_accvgpr_read_b32 v28, a0
    v_accvgpr_read_b32 v29, a1
    v_accvgpr_read_b32 v30, a2
    v_accvgpr_read_b32 v31, a3
    v_pk_mul_f32 v[28:29], v[28:29], v[68:69] op_sel:[0,1] op_sel_hi:[1,1]
    v_pk_mul_f32 v[30:31], v[30:31], v[68:69] op_sel:[0,1] op_sel_hi:[1,1]
    v_cvt_pk_bf16_f32 v28, v28, v29
    v_cvt_pk_bf16_f32 v29, v30, v31
    ds_write_b64 v8, v[28:29] offset:0
    v_accvgpr_read_b32 v32, a4
    v_accvgpr_read_b32 v33, a5
    v_accvgpr_read_b32 v34, a6
    v_accvgpr_read_b32 v35, a7
    v_pk_mul_f32 v[32:33], v[32:33], v[68:69] op_sel:[0,1] op_sel_hi:[1,1]
    v_pk_mul_f32 v[34:35], v[34:35], v[68:69] op_sel:[0,1] op_sel_hi:[1,1]
    v_cvt_pk_bf16_f32 v32, v32, v33
    v_cvt_pk_bf16_f32 v33, v34, v35
    ds_write_b64 v8, v[32:33] offset:32
    v_accvgpr_read_b32 v28, a8
    v_accvgpr_read_b32 v29, a9
    v_accvgpr_read_b32 v30, a10
    v_accvgpr_read_b32 v31, a11
    v_pk_mul_f32 v[28:29], v[28:29], v[68:69] op_sel:[0,1] op_sel_hi:[1,1]
    v_pk_mul_f32 v[30:31], v[30:31], v[68:69] op_sel:[0,1] op_sel_hi:[1,1]
    v_cvt_pk_bf16_f32 v28, v28, v29
    v_cvt_pk_bf16_f32 v29, v30, v31
    ds_write_b64 v8, v[28:29] offset:64
    v_accvgpr_read_b32 v32, a12
    v_accvgpr_read_b32 v33, a13
    v_accvgpr_read_b32 v34, a14
    v_accvgpr_read_b32 v35, a15
    v_pk_mul_f32 v[32:33], v[32:33], v[68:69] op_sel:[0,1] op_sel_hi:[1,1]
    v_pk_mul_f32 v[34:35], v[34:35], v[68:69] op_sel:[0,1] op_sel_hi:[1,1]
    v_cvt_pk_bf16_f32 v32, v32, v33
    v_cvt_pk_bf16_f32 v33, v34, v35
    ds_write_b64 v8, v[32:33] offset:96
    v_accvgpr_read_b32 v28, a16
    v_accvgpr_read_b32 v29, a17
    v_accvgpr_read_b32 v30, a18
    v_accvgpr_read_b32 v31, a19
    v_pk_mul_f32 v[28:29], v[28:29], v[68:69] op_sel:[0,1] op_sel_hi:[1,1]
    v_pk_mul_f32 v[30:31], v[30:31], v[68:69] op_sel:[0,1] op_sel_hi:[1,1]
    v_cvt_pk_bf16_f32 v28, v28, v29
    v_cvt_pk_bf16_f32 v29, v30, v31
    ds_write_b64 v8, v[28:29] offset:128
    v_accvgpr_read_b32 v32, a20
    v_accvgpr_read_b32 v33, a21
    v_accvgpr_read_b32 v34, a22
    v_accvgpr_read_b32 v35, a23
    v_pk_mul_f32 v[32:33], v[32:33], v[68:69] op_sel:[0,1] op_sel_hi:[1,1]
    v_pk_mul_f32 v[34:35], v[34:35], v[68:69] op_sel:[0,1] op_sel_hi:[1,1]
    v_cvt_pk_bf16_f32 v32, v32, v33
    v_cvt_pk_bf16_f32 v33, v34, v35
    ds_write_b64 v8, v[32:33] offset:160
    v_accvgpr_read_b32 v28, a24
    v_accvgpr_read_b32 v29, a25
    v_accvgpr_read_b32 v30, a26
    v_accvgpr_read_b32 v31, a27
    v_pk_mul_f32 v[28:29], v[28:29], v[68:69] op_sel:[0,1] op_sel_hi:[1,1]
    v_pk_mul_f32 v[30:31], v[30:31], v[68:69] op_sel:[0,1] op_sel_hi:[1,1]
    v_cvt_pk_bf16_f32 v28, v28, v29
    v_cvt_pk_bf16_f32 v29, v30, v31
    ds_write_b64 v8, v[28:29] offset:192
    v_accvgpr_read_b32 v32, a28
    v_accvgpr_read_b32 v33, a29
    v_accvgpr_read_b32 v34, a30
    v_accvgpr_read_b32 v35, a31
    v_pk_mul_f32 v[32:33], v[32:33], v[68:69] op_sel:[0,1] op_sel_hi:[1,1]
    v_pk_mul_f32 v[34:35], v[34:35], v[68:69] op_sel:[0,1] op_sel_hi:[1,1]
    v_cvt_pk_bf16_f32 v32, v32, v33
    v_cvt_pk_bf16_f32 v33, v34, v35
    ds_write_b64 v8, v[32:33] offset:224
    v_mfma_f32_16x16x32_bf16 v[56:59], a[148:151], a[100:103], v[56:59]
    ds_read_b128 a[0:3], v6 offset:0
    ds_read_b128 a[4:7], v6 offset:1088
    v_mfma_f32_16x16x32_bf16 v[56:59], a[152:155], a[104:107], v[56:59]
    ds_read_b128 a[8:11], v6 offset:2176
    ds_read_b128 a[12:15], v6 offset:3264
    v_mfma_f32_16x16x32_bf16 v[56:59], a[156:159], a[108:111], v[56:59]
    v_fma_f32 v51, v51, s35, v80
    v_cvt_pk_bf16_f32 v45, v46, v47
    v_mfma_f32_16x16x32_bf16 v[60:63], a[128:131], a[112:115], 0
    ds_read_b128 a[128:131], v9 offset:0
    v_cvt_pk_bf16_f32 v46, v48, v49
    v_mfma_f32_16x16x32_bf16 v[60:63], a[132:135], a[116:119], v[60:63]
    v_exp_f32 v51, v51
    v_mfma_f32_16x16x32_bf16 v[60:63], a[136:139], a[120:123], v[60:63]
    ds_read_b128 a[132:135], v10 offset:0
    v_cvt_pk_bf16_f32 v47, v50, v51
    v_mfma_f32_16x16x32_bf16 v[60:63], a[140:143], a[124:127], v[60:63]
    v_fma_f32 v52, v52, s35, v84
    v_fma_f32 v53, v53, s35, v84
    v_mfma_f32_16x16x32_bf16 v[64:67], a[144:147], a[112:115], 0
    v_exp_f32 v52, v52
    v_mfma_f32_16x16x32_bf16 v[64:67], a[148:151], a[116:119], v[64:67]
    ds_read_b128 a[136:139], v11 offset:0
    v_fma_f32 v54, v54, s35, v84
    v_mfma_f32_16x16x32_bf16 v[64:67], a[152:155], a[120:123], v[64:67]
    v_exp_f32 v53, v53
    v_mfma_f32_16x16x32_bf16 v[64:67], a[156:159], a[124:127], v[64:67]
    v_exp_f32 v54, v54
    v_mfma_f32_16x16x32_bf16 a[200:203], a[216:219], v[36:39], a[200:203]
    ds_read_b128 a[140:143], v12 offset:0
    v_fma_f32 v55, v55, s35, v84
    v_mfma_f32_16x16x32_bf16 a[204:207], a[216:219], v[44:47], a[204:207]
    s_waitcnt lgkmcnt(7)
    buffer_store_dwordx4 a[0:3], v1, s[24:27], s56 offen offset:0 nt
    v_mfma_f32_16x16x32_bf16 v[128:131], a[160:163], v[36:39], v[128:131]
    ds_read_b128 a[144:147], v9 offset:4096
    v_fma_f32 v56, v56, s35, v84
    v_mfma_f32_16x16x32_bf16 v[160:163], a[160:163], v[44:47], v[160:163]
    v_exp_f32 v55, v55
    v_mfma_f32_16x16x32_bf16 v[164:167], a[164:167], v[44:47], v[164:167]
    v_exp_f32 v56, v56
    v_mfma_f32_16x16x32_bf16 v[132:135], a[164:167], v[36:39], v[132:135]
    ds_read_b128 a[148:151], v10 offset:4096
    v_fma_f32 v57, v57, s35, v84
    v_mfma_f32_16x16x32_bf16 v[136:139], a[168:171], v[36:39], v[136:139]
    s_waitcnt lgkmcnt(8)
    buffer_store_dwordx4 a[4:7], v1, s[24:27], s56 offen offset:1024 nt
    v_mfma_f32_16x16x32_bf16 v[168:171], a[168:171], v[44:47], v[168:171]
    v_exp_f32 v57, v57
    v_mfma_f32_16x16x32_bf16 v[172:175], a[172:175], v[44:47], v[172:175]
    ds_read_b128 a[152:155], v11 offset:4096
    v_cvt_pk_bf16_f32 v52, v52, v53
    v_pk_mul_f32 v[96:97], v[96:97], v[72:73] op_sel:[0,1] op_sel_hi:[1,1]
    v_pk_mul_f32 v[98:99], v[98:99], v[72:73] op_sel:[0,1] op_sel_hi:[1,1]
    v_cvt_pk_bf16_f32 v96, v96, v97
    v_cvt_pk_bf16_f32 v97, v98, v99
    ds_write_b64 v8, v[96:97] offset:4352
    v_pk_mul_f32 v[100:101], v[100:101], v[72:73] op_sel:[0,1] op_sel_hi:[1,1]
    v_pk_mul_f32 v[102:103], v[102:103], v[72:73] op_sel:[0,1] op_sel_hi:[1,1]
    v_cvt_pk_bf16_f32 v100, v100, v101
    v_cvt_pk_bf16_f32 v101, v102, v103
    ds_write_b64 v8, v[100:101] offset:4384
    v_pk_mul_f32 v[104:105], v[104:105], v[72:73] op_sel:[0,1] op_sel_hi:[1,1]
    v_pk_mul_f32 v[106:107], v[106:107], v[72:73] op_sel:[0,1] op_sel_hi:[1,1]
    v_cvt_pk_bf16_f32 v104, v104, v105
    v_cvt_pk_bf16_f32 v105, v106, v107
    ds_write_b64 v8, v[104:105] offset:4416
    v_pk_mul_f32 v[108:109], v[108:109], v[72:73] op_sel:[0,1] op_sel_hi:[1,1]
    v_pk_mul_f32 v[110:111], v[110:111], v[72:73] op_sel:[0,1] op_sel_hi:[1,1]
    v_cvt_pk_bf16_f32 v108, v108, v109
    v_cvt_pk_bf16_f32 v109, v110, v111
    ds_write_b64 v8, v[108:109] offset:4448
    v_pk_mul_f32 v[112:113], v[112:113], v[72:73] op_sel:[0,1] op_sel_hi:[1,1]
    v_pk_mul_f32 v[114:115], v[114:115], v[72:73] op_sel:[0,1] op_sel_hi:[1,1]
    v_cvt_pk_bf16_f32 v112, v112, v113
    v_cvt_pk_bf16_f32 v113, v114, v115
    ds_write_b64 v8, v[112:113] offset:4480
    v_pk_mul_f32 v[116:117], v[116:117], v[72:73] op_sel:[0,1] op_sel_hi:[1,1]
    v_pk_mul_f32 v[118:119], v[118:119], v[72:73] op_sel:[0,1] op_sel_hi:[1,1]
    v_cvt_pk_bf16_f32 v116, v116, v117
    v_cvt_pk_bf16_f32 v117, v118, v119
    ds_write_b64 v8, v[116:117] offset:4512
    v_pk_mul_f32 v[120:121], v[120:121], v[72:73] op_sel:[0,1] op_sel_hi:[1,1]
    v_pk_mul_f32 v[122:123], v[122:123], v[72:73] op_sel:[0,1] op_sel_hi:[1,1]
    v_cvt_pk_bf16_f32 v120, v120, v121
    v_cvt_pk_bf16_f32 v121, v122, v123
    ds_write_b64 v8, v[120:121] offset:4544
    v_pk_mul_f32 v[124:125], v[124:125], v[72:73] op_sel:[0,1] op_sel_hi:[1,1]
    v_pk_mul_f32 v[126:127], v[126:127], v[72:73] op_sel:[0,1] op_sel_hi:[1,1]
    v_cvt_pk_bf16_f32 v124, v124, v125
    v_cvt_pk_bf16_f32 v125, v126, v127
    ds_write_b64 v8, v[124:125] offset:4576
    v_mfma_f32_16x16x32_bf16 v[140:143], a[172:175], v[36:39], v[140:143]
    ds_read_b128 v[96:99], v6 offset:4352
    ds_read_b128 v[100:103], v6 offset:5440
    v_mfma_f32_16x16x32_bf16 v[144:147], a[176:179], v[36:39], v[144:147]
    ds_read_b128 v[104:107], v6 offset:6528
    ds_read_b128 v[108:111], v6 offset:7616
    v_mfma_f32_16x16x32_bf16 v[176:179], a[176:179], v[44:47], v[176:179]
    ds_read_b128 a[156:159], v12 offset:4096
    v_fma_f32 v58, v58, s35, v84
    v_mfma_f32_16x16x32_bf16 v[180:183], a[180:183], v[44:47], v[180:183]
    s_waitcnt lgkmcnt(15)
    buffer_store_dwordx4 a[8:11], v1, s[24:27], s56 offen offset:2048 nt
    v_mfma_f32_16x16x32_bf16 v[148:151], a[180:183], v[36:39], v[148:151]
    v_exp_f32 v58, v58
    v_mfma_f32_16x16x32_bf16 v[152:155], a[184:187], v[36:39], v[152:155]
    v_fma_f32 v59, v59, s35, v84
    v_cvt_pk_bf16_f32 v53, v54, v55
    v_mfma_f32_16x16x32_bf16 v[184:187], a[184:187], v[44:47], v[184:187]
    v_exp_f32 v59, v59
    v_mfma_f32_16x16x32_bf16 v[188:191], a[188:191], v[44:47], v[188:191]
    v_cvt_pk_bf16_f32 v54, v56, v57
    v_cvt_pk_bf16_f32 v55, v58, v59
    v_mfma_f32_16x16x32_bf16 v[156:159], a[188:191], v[36:39], v[156:159]
    buffer_store_dwordx4 a[12:15], v1, s[24:27], s56 offen offset:3072 nt
    s_waitcnt lgkmcnt(0)
    v_mfma_f32_16x16x32_bf16 v[36:39], a[128:131], a[64:67], 0
    v_fma_f32 v60, v60, s35, v88
    v_fma_f32 v61, v61, s35, v88
    v_mfma_f32_16x16x32_bf16 v[36:39], a[132:135], a[68:71], v[36:39]
    v_exp_f32 v60, v60
    v_mfma_f32_16x16x32_bf16 v[36:39], a[136:139], a[72:75], v[36:39]
    v_exp_f32 v61, v61
    v_mfma_f32_16x16x32_bf16 v[36:39], a[140:143], a[76:79], v[36:39]
    v_fma_f32 v62, v62, s35, v88
    v_fma_f32 v63, v63, s35, v88
    v_mfma_f32_16x16x32_bf16 v[40:43], a[144:147], a[64:67], 0
    buffer_store_dwordx4 v[96:99], v1, s[24:27], s57 offen offset:0 nt
    v_mfma_f32_16x16x32_bf16 v[40:43], a[148:151], a[68:71], v[40:43]
    v_exp_f32 v62, v62
    v_mfma_f32_16x16x32_bf16 v[40:43], a[152:155], a[72:75], v[40:43]
    v_exp_f32 v63, v63
    v_mfma_f32_16x16x32_bf16 v[40:43], a[156:159], a[76:79], v[40:43]
    v_fma_f32 v64, v64, s35, v88
    v_fma_f32 v65, v65, s35, v88
    v_mfma_f32_16x16x32_bf16 v[44:47], a[128:131], a[80:83], 0
    v_exp_f32 v64, v64
    v_mfma_f32_16x16x32_bf16 v[44:47], a[132:135], a[84:87], v[44:47]
    buffer_store_dwordx4 v[100:103], v1, s[24:27], s57 offen offset:1024 nt
    v_mfma_f32_16x16x32_bf16 v[44:47], a[136:139], a[88:91], v[44:47]
    v_exp_f32 v65, v65
    v_mfma_f32_16x16x32_bf16 v[44:47], a[140:143], a[92:95], v[44:47]
    v_cvt_pk_bf16_f32 v60, v60, v61
    v_fma_f32 v66, v66, s35, v88
    v_mfma_f32_16x16x32_bf16 v[48:51], a[144:147], a[80:83], 0
    v_exp_f32 v66, v66
    v_mfma_f32_16x16x32_bf16 v[48:51], a[148:151], a[84:87], v[48:51]
    v_fma_f32 v67, v67, s35, v88
    v_cvt_pk_bf16_f32 v61, v62, v63
    v_mfma_f32_16x16x32_bf16 v[48:51], a[152:155], a[88:91], v[48:51]
    buffer_store_dwordx4 v[104:107], v1, s[24:27], s57 offen offset:2048 nt
    v_mfma_f32_16x16x32_bf16 v[48:51], a[156:159], a[92:95], v[48:51]
    v_cvt_pk_bf16_f32 v62, v64, v65
    v_fma_f32 v36, v36, s35, v76
    v_mfma_f32_16x16x32_bf16 a[208:211], a[216:219], v[52:55], a[208:211]
    v_exp_f32 v67, v67
    v_fma_f32 v37, v37, s35, v76
    v_cvt_pk_bf16_f32 v63, v66, v67
    v_fma_f32 v38, v38, s35, v76
    v_fma_f32 v39, v39, s35, v76
    v_mfma_f32_16x16x32_bf16 a[212:215], a[216:219], v[60:63], a[212:215]
    v_exp_f32 v36, v36
    v_mfma_f32_16x16x32_bf16 v[192:195], a[160:163], v[52:55], v[192:195]
    v_exp_f32 v37, v37
    v_mfma_f32_16x16x32_bf16 v[224:227], a[160:163], v[60:63], v[224:227]
    ds_read_b64_tr_b16 a[160:161], v13 offset:0
    v_fma_f32 v40, v40, s35, v76
    v_mfma_f32_16x16x32_bf16 v[228:231], a[164:167], v[60:63], v[228:231]
    ds_read_b64_tr_b16 a[162:163], v13 offset:4096
    v_fma_f32 v41, v41, s35, v76
    v_mfma_f32_16x16x32_bf16 v[196:199], a[164:167], v[52:55], v[196:199]
    buffer_store_dwordx4 v[108:111], v1, s[24:27], s57 offen offset:3072 nt
    v_mfma_f32_16x16x32_bf16 v[200:203], a[168:171], v[52:55], v[200:203]
    ds_read_b64_tr_b16 a[164:165], v14 offset:0
    v_cvt_pk_bf16_f32 v36, v36, v37
    v_mfma_f32_16x16x32_bf16 v[232:235], a[168:171], v[60:63], v[232:235]
    v_exp_f32 v38, v38
    v_mfma_f32_16x16x32_bf16 v[236:239], a[172:175], v[60:63], v[236:239]
    ds_read_b64_tr_b16 a[166:167], v14 offset:4096
    v_fma_f32 v42, v42, s35, v76
    v_mfma_f32_16x16x32_bf16 v[204:207], a[172:175], v[52:55], v[204:207]
    v_exp_f32 v39, v39
    v_mfma_f32_16x16x32_bf16 v[208:211], a[176:179], v[52:55], v[208:211]
    ds_read_b64_tr_b16 a[168:169], v15 offset:0
    v_fma_f32 v43, v43, s35, v76
    v_mfma_f32_16x16x32_bf16 v[240:243], a[176:179], v[60:63], v[240:243]
    v_exp_f32 v40, v40
    v_mfma_f32_16x16x32_bf16 v[244:247], a[180:183], v[60:63], v[244:247]
    ds_read_b64_tr_b16 a[170:171], v15 offset:4096
    v_cvt_pk_bf16_f32 v37, v38, v39
    v_mfma_f32_16x16x32_bf16 v[212:215], a[180:183], v[52:55], v[212:215]
    ds_read_b64_tr_b16 a[172:173], v16 offset:0
    v_fma_f32 v44, v44, s35, v80
    v_mfma_f32_16x16x32_bf16 v[216:219], a[184:187], v[52:55], v[216:219]
    v_exp_f32 v41, v41
    v_mfma_f32_16x16x32_bf16 v[248:251], a[184:187], v[60:63], v[248:251]
    ds_read_b64_tr_b16 a[174:175], v16 offset:4096
    v_cvt_pk_bf16_f32 v38, v40, v41
    v_mfma_f32_16x16x32_bf16 v[252:255], a[188:191], v[60:63], v[252:255]
    v_exp_f32 v42, v42
    v_mfma_f32_16x16x32_bf16 v[220:223], a[188:191], v[52:55], v[220:223]
    ds_read_b64_tr_b16 a[176:177], v17 offset:0
    v_fma_f32 v45, v45, s35, v80
    v_mfma_f32_16x16x32_bf16 v[52:55], a[128:131], a[96:99], 0
    v_exp_f32 v43, v43
    v_mfma_f32_16x16x32_bf16 v[52:55], a[132:135], a[100:103], v[52:55]
    ds_read_b64_tr_b16 a[178:179], v17 offset:4096
    v_cvt_pk_bf16_f32 v39, v42, v43
    v_mfma_f32_16x16x32_bf16 v[52:55], a[136:139], a[104:107], v[52:55]
    v_exp_f32 v44, v44
    v_mfma_f32_16x16x32_bf16 v[52:55], a[140:143], a[108:111], v[52:55]
    ds_read_b64_tr_b16 a[180:181], v18 offset:0
    v_fma_f32 v46, v46, s35, v80
    v_mfma_f32_16x16x32_bf16 v[56:59], a[144:147], a[96:99], 0
    ds_read_b64_tr_b16 a[182:183], v18 offset:4096
    v_fma_f32 v47, v47, s35, v80
    v_mfma_f32_16x16x32_bf16 v[56:59], a[148:151], a[100:103], v[56:59]
    v_exp_f32 v45, v45
    v_mfma_f32_16x16x32_bf16 v[56:59], a[152:155], a[104:107], v[56:59]
    ds_read_b64_tr_b16 a[184:185], v19 offset:0
    v_fma_f32 v48, v48, s35, v80
    v_mfma_f32_16x16x32_bf16 v[56:59], a[156:159], a[108:111], v[56:59]
    v_exp_f32 v46, v46
    v_mfma_f32_16x16x32_bf16 v[60:63], a[128:131], a[112:115], 0
    ds_read_b64_tr_b16 a[186:187], v19 offset:4096
    ds_read_b128 a[128:131], v9 offset:8192
    v_mfma_f32_16x16x32_bf16 v[60:63], a[132:135], a[116:119], v[60:63]
    v_exp_f32 v47, v47
    v_mfma_f32_16x16x32_bf16 v[60:63], a[136:139], a[120:123], v[60:63]
    ds_read_b64_tr_b16 a[188:189], v20 offset:0
    ds_read_b128 a[132:135], v10 offset:8192
    v_mfma_f32_16x16x32_bf16 v[60:63], a[140:143], a[124:127], v[60:63]
    v_exp_f32 v48, v48
    v_mfma_f32_16x16x32_bf16 v[64:67], a[144:147], a[112:115], 0
    ds_read_b64_tr_b16 a[190:191], v20 offset:4096
    v_fma_f32 v49, v49, s35, v80
    v_mfma_f32_16x16x32_bf16 v[64:67], a[148:151], a[116:119], v[64:67]
    ds_read_b128 a[136:139], v11 offset:8192
    v_cvt_pk_bf16_f32 v44, v44, v45
    v_mfma_f32_16x16x32_bf16 v[64:67], a[152:155], a[120:123], v[64:67]
    v_exp_f32 v49, v49
    v_mfma_f32_16x16x32_bf16 v[64:67], a[156:159], a[124:127], v[64:67]
    v_fma_f32 v50, v50, s35, v80
    v_fma_f32 v51, v51, s35, v80
    v_mfma_f32_16x16x32_bf16 a[200:203], a[216:219], v[36:39], a[200:203]
    ds_read_b128 a[140:143], v12 offset:8192
    v_cvt_pk_bf16_f32 v45, v46, v47
    v_cvt_pk_bf16_f32 v46, v48, v49
    v_exp_f32 v50, v50
    v_exp_f32 v51, v51
    v_fma_f32 v52, v52, s35, v84
    v_cvt_pk_bf16_f32 v47, v50, v51
    v_fma_f32 v53, v53, s35, v84
    v_fma_f32 v54, v54, s35, v84
    v_mfma_f32_16x16x32_bf16 a[204:207], a[216:219], v[44:47], a[204:207]
    s_waitcnt lgkmcnt(2)
    v_fma_f32 v55, v55, s35, v84
    v_mfma_f32_16x16x32_bf16 v[128:131], a[160:163], v[36:39], v[128:131]
    ds_read_b128 a[144:147], v9 offset:12288
    v_fma_f32 v56, v56, s35, v84
    v_mfma_f32_16x16x32_bf16 v[160:163], a[160:163], v[44:47], v[160:163]
    v_exp_f32 v52, v52
    v_mfma_f32_16x16x32_bf16 v[164:167], a[164:167], v[44:47], v[164:167]
    v_exp_f32 v53, v53
    v_mfma_f32_16x16x32_bf16 v[132:135], a[164:167], v[36:39], v[132:135]
    ds_read_b128 a[148:151], v10 offset:12288
    v_fma_f32 v57, v57, s35, v84
    v_mfma_f32_16x16x32_bf16 v[136:139], a[168:171], v[36:39], v[136:139]
    v_exp_f32 v54, v54
    v_mfma_f32_16x16x32_bf16 v[168:171], a[168:171], v[44:47], v[168:171]
    v_exp_f32 v55, v55
    v_mfma_f32_16x16x32_bf16 v[172:175], a[172:175], v[44:47], v[172:175]
    ds_read_b128 a[152:155], v11 offset:12288
    v_cvt_pk_bf16_f32 v52, v52, v53
    v_mfma_f32_16x16x32_bf16 v[140:143], a[172:175], v[36:39], v[140:143]
    v_exp_f32 v56, v56
    v_mfma_f32_16x16x32_bf16 v[144:147], a[176:179], v[36:39], v[144:147]
    v_exp_f32 v57, v57
    v_mfma_f32_16x16x32_bf16 v[176:179], a[176:179], v[44:47], v[176:179]
    ds_read_b128 a[156:159], v12 offset:12288
    v_fma_f32 v58, v58, s35, v84
    v_mfma_f32_16x16x32_bf16 v[180:183], a[180:183], v[44:47], v[180:183]
    v_exp_f32 v58, v58
    v_mfma_f32_16x16x32_bf16 v[148:151], a[180:183], v[36:39], v[148:151]
    v_fma_f32 v59, v59, s35, v84
    v_cvt_pk_bf16_f32 v53, v54, v55
    v_mfma_f32_16x16x32_bf16 v[152:155], a[184:187], v[36:39], v[152:155]
    v_exp_f32 v59, v59
    v_mfma_f32_16x16x32_bf16 v[184:187], a[184:187], v[44:47], v[184:187]
    v_cvt_pk_bf16_f32 v54, v56, v57
    v_cvt_pk_bf16_f32 v55, v58, v59
    v_mfma_f32_16x16x32_bf16 v[188:191], a[188:191], v[44:47], v[188:191]
    v_fma_f32 v60, v60, s35, v88
    v_fma_f32 v61, v61, s35, v88
    v_mfma_f32_16x16x32_bf16 v[156:159], a[188:191], v[36:39], v[156:159]
    s_waitcnt lgkmcnt(0)
    v_fma_f32 v62, v62, s35, v88
    v_mfma_f32_16x16x32_bf16 v[36:39], a[128:131], a[64:67], 0
    v_exp_f32 v60, v60
    v_mfma_f32_16x16x32_bf16 v[36:39], a[132:135], a[68:71], v[36:39]
    v_exp_f32 v61, v61
    v_mfma_f32_16x16x32_bf16 v[36:39], a[136:139], a[72:75], v[36:39]
    v_exp_f32 v62, v62
    v_mfma_f32_16x16x32_bf16 v[36:39], a[140:143], a[76:79], v[36:39]
    v_fma_f32 v63, v63, s35, v88
    v_fma_f32 v64, v64, s35, v88
    v_mfma_f32_16x16x32_bf16 v[40:43], a[144:147], a[64:67], 0
    v_exp_f32 v63, v63
    v_mfma_f32_16x16x32_bf16 v[40:43], a[148:151], a[68:71], v[40:43]
    v_exp_f32 v64, v64
    v_mfma_f32_16x16x32_bf16 v[40:43], a[152:155], a[72:75], v[40:43]
    v_fma_f32 v65, v65, s35, v88
    v_cvt_pk_bf16_f32 v60, v60, v61
    v_mfma_f32_16x16x32_bf16 v[40:43], a[156:159], a[76:79], v[40:43]
    v_exp_f32 v65, v65
    v_mfma_f32_16x16x32_bf16 v[44:47], a[128:131], a[80:83], 0
    v_fma_f32 v66, v66, s35, v88
    v_fma_f32 v67, v67, s35, v88
    v_mfma_f32_16x16x32_bf16 v[44:47], a[132:135], a[84:87], v[44:47]
    v_exp_f32 v66, v66
    v_mfma_f32_16x16x32_bf16 v[44:47], a[136:139], a[88:91], v[44:47]
    v_exp_f32 v67, v67
    v_mfma_f32_16x16x32_bf16 v[44:47], a[140:143], a[92:95], v[44:47]
    v_cvt_pk_bf16_f32 v61, v62, v63
    v_cvt_pk_bf16_f32 v62, v64, v65
    v_mfma_f32_16x16x32_bf16 v[48:51], a[144:147], a[80:83], 0
    v_cvt_pk_bf16_f32 v63, v66, v67
    v_fma_f32 v36, v36, s35, v76
    v_mfma_f32_16x16x32_bf16 v[48:51], a[148:151], a[84:87], v[48:51]
    v_exp_f32 v36, v36
    v_mfma_f32_16x16x32_bf16 v[48:51], a[152:155], a[88:91], v[48:51]
    v_fma_f32 v37, v37, s35, v76
    v_fma_f32 v38, v38, s35, v76
    v_mfma_f32_16x16x32_bf16 v[48:51], a[156:159], a[92:95], v[48:51]
    v_exp_f32 v37, v37
    v_mfma_f32_16x16x32_bf16 a[208:211], a[216:219], v[52:55], a[208:211]
    v_exp_f32 v38, v38
    v_mfma_f32_16x16x32_bf16 a[212:215], a[216:219], v[60:63], a[212:215]
    v_fma_f32 v39, v39, s35, v76
    v_fma_f32 v40, v40, s35, v76
    v_mfma_f32_16x16x32_bf16 v[192:195], a[160:163], v[52:55], v[192:195]
    v_exp_f32 v39, v39
    v_mfma_f32_16x16x32_bf16 v[224:227], a[160:163], v[60:63], v[224:227]
    ds_read_b64_tr_b16 a[160:161], v13 offset:8192
    v_fma_f32 v41, v41, s35, v76
    v_mfma_f32_16x16x32_bf16 v[228:231], a[164:167], v[60:63], v[228:231]
    ds_read_b64_tr_b16 a[162:163], v13 offset:12288
    v_cvt_pk_bf16_f32 v36, v36, v37
    v_mfma_f32_16x16x32_bf16 v[196:199], a[164:167], v[52:55], v[196:199]
    v_exp_f32 v40, v40
    v_mfma_f32_16x16x32_bf16 v[200:203], a[168:171], v[52:55], v[200:203]
    ds_read_b64_tr_b16 a[164:165], v14 offset:8192
    v_fma_f32 v42, v42, s35, v76
    v_mfma_f32_16x16x32_bf16 v[232:235], a[168:171], v[60:63], v[232:235]
    v_exp_f32 v41, v41
    v_mfma_f32_16x16x32_bf16 v[236:239], a[172:175], v[60:63], v[236:239]
    ds_read_b64_tr_b16 a[166:167], v14 offset:12288
    v_fma_f32 v43, v43, s35, v76
    v_mfma_f32_16x16x32_bf16 v[204:207], a[172:175], v[52:55], v[204:207]
    v_exp_f32 v42, v42
    v_mfma_f32_16x16x32_bf16 v[208:211], a[176:179], v[52:55], v[208:211]
    ds_read_b64_tr_b16 a[168:169], v15 offset:8192
    v_cvt_pk_bf16_f32 v37, v38, v39
    v_mfma_f32_16x16x32_bf16 v[240:243], a[176:179], v[60:63], v[240:243]
    v_exp_f32 v43, v43
    v_mfma_f32_16x16x32_bf16 v[244:247], a[180:183], v[60:63], v[244:247]
    ds_read_b64_tr_b16 a[170:171], v15 offset:12288
    v_cvt_pk_bf16_f32 v38, v40, v41
    v_mfma_f32_16x16x32_bf16 v[212:215], a[180:183], v[52:55], v[212:215]
    ds_read_b64_tr_b16 a[172:173], v16 offset:8192
    v_cvt_pk_bf16_f32 v39, v42, v43
    v_mfma_f32_16x16x32_bf16 v[216:219], a[184:187], v[52:55], v[216:219]
    v_fma_f32 v44, v44, s35, v80
    v_fma_f32 v45, v45, s35, v80
    v_mfma_f32_16x16x32_bf16 v[248:251], a[184:187], v[60:63], v[248:251]
    ds_read_b64_tr_b16 a[174:175], v16 offset:12288
    v_fma_f32 v46, v46, s35, v80
    v_mfma_f32_16x16x32_bf16 v[252:255], a[188:191], v[60:63], v[252:255]
    v_exp_f32 v44, v44
    v_mfma_f32_16x16x32_bf16 v[220:223], a[188:191], v[52:55], v[220:223]
    ds_read_b64_tr_b16 a[176:177], v17 offset:8192
    v_fma_f32 v47, v47, s35, v80
    v_mfma_f32_16x16x32_bf16 v[52:55], a[128:131], a[96:99], 0
    v_exp_f32 v45, v45
    v_mfma_f32_16x16x32_bf16 v[52:55], a[132:135], a[100:103], v[52:55]
    ds_read_b64_tr_b16 a[178:179], v17 offset:12288
    v_fma_f32 v48, v48, s35, v80
    v_mfma_f32_16x16x32_bf16 v[52:55], a[136:139], a[104:107], v[52:55]
    v_exp_f32 v46, v46
    v_mfma_f32_16x16x32_bf16 v[52:55], a[140:143], a[108:111], v[52:55]
    ds_read_b64_tr_b16 a[180:181], v18 offset:8192
    v_fma_f32 v49, v49, s35, v80
    v_mfma_f32_16x16x32_bf16 v[56:59], a[144:147], a[96:99], 0
    ds_read_b64_tr_b16 a[182:183], v18 offset:12288
    v_cvt_pk_bf16_f32 v44, v44, v45
    v_mfma_f32_16x16x32_bf16 v[56:59], a[148:151], a[100:103], v[56:59]
    v_exp_f32 v47, v47
    v_mfma_f32_16x16x32_bf16 v[56:59], a[152:155], a[104:107], v[56:59]
    ds_read_b64_tr_b16 a[184:185], v19 offset:8192
    v_fma_f32 v50, v50, s35, v80
    v_mfma_f32_16x16x32_bf16 v[56:59], a[156:159], a[108:111], v[56:59]
    v_exp_f32 v48, v48
    v_mfma_f32_16x16x32_bf16 v[60:63], a[128:131], a[112:115], 0
    ds_read_b64_tr_b16 a[186:187], v19 offset:12288
    ds_read_b128 a[128:131], v9 offset:16384
    v_mfma_f32_16x16x32_bf16 v[60:63], a[132:135], a[116:119], v[60:63]
    v_exp_f32 v49, v49
    v_mfma_f32_16x16x32_bf16 v[60:63], a[136:139], a[120:123], v[60:63]
    ds_read_b64_tr_b16 a[188:189], v20 offset:8192
    ds_read_b128 a[132:135], v10 offset:16384
    v_mfma_f32_16x16x32_bf16 v[60:63], a[140:143], a[124:127], v[60:63]
    v_exp_f32 v50, v50
    v_mfma_f32_16x16x32_bf16 v[64:67], a[144:147], a[112:115], 0
    ds_read_b64_tr_b16 a[190:191], v20 offset:12288
    v_fma_f32 v51, v51, s35, v80
    v_mfma_f32_16x16x32_bf16 v[64:67], a[148:151], a[116:119], v[64:67]
    ds_read_b128 a[136:139], v11 offset:16384
    v_cvt_pk_bf16_f32 v45, v46, v47
    v_mfma_f32_16x16x32_bf16 v[64:67], a[152:155], a[120:123], v[64:67]
    v_exp_f32 v51, v51
    v_mfma_f32_16x16x32_bf16 v[64:67], a[156:159], a[124:127], v[64:67]
    v_cvt_pk_bf16_f32 v46, v48, v49
    v_cvt_pk_bf16_f32 v47, v50, v51
    v_mfma_f32_16x16x32_bf16 a[200:203], a[216:219], v[36:39], a[200:203]
    ds_read_b128 a[140:143], v12 offset:16384
    v_fma_f32 v52, v52, s35, v84
    v_mfma_f32_16x16x32_bf16 a[204:207], a[216:219], v[44:47], a[204:207]
    s_waitcnt lgkmcnt(2)
    v_fma_f32 v53, v53, s35, v84
    v_mfma_f32_16x16x32_bf16 v[128:131], a[160:163], v[36:39], v[128:131]
    ds_read_b128 a[144:147], v9 offset:20480
    v_fma_f32 v54, v54, s35, v84
    v_mfma_f32_16x16x32_bf16 v[160:163], a[160:163], v[44:47], v[160:163]
    v_exp_f32 v52, v52
    v_mfma_f32_16x16x32_bf16 v[164:167], a[164:167], v[44:47], v[164:167]
    v_exp_f32 v53, v53
    v_mfma_f32_16x16x32_bf16 v[132:135], a[164:167], v[36:39], v[132:135]
    ds_read_b128 a[148:151], v10 offset:20480
    v_accvgpr_read_b32 v78, a200
    v_mfma_f32_16x16x32_bf16 v[136:139], a[168:171], v[36:39], v[136:139]
    v_rcp_f32 v77, v78
    v_mfma_f32_16x16x32_bf16 v[168:171], a[168:171], v[44:47], v[168:171]
    v_exp_f32 v54, v54
    v_mfma_f32_16x16x32_bf16 v[172:175], a[172:175], v[44:47], v[172:175]
    ds_read_b128 a[152:155], v11 offset:20480
    v_accvgpr_read_b32 v82, a204
    v_mfma_f32_16x16x32_bf16 v[140:143], a[172:175], v[36:39], v[140:143]
    v_rcp_f32 v81, v82
    v_mfma_f32_16x16x32_bf16 v[144:147], a[176:179], v[36:39], v[144:147]
    v_cmp_nge_f32 s[66:67], s3, v78
    v_cmp_nge_f32 s[68:69], s3, v82
    v_mfma_f32_16x16x32_bf16 v[176:179], a[176:179], v[44:47], v[176:179]
    ds_read_b128 a[156:159], v12 offset:20480
    v_fma_f32 v55, v55, s35, v84
    v_mfma_f32_16x16x32_bf16 v[180:183], a[180:183], v[44:47], v[180:183]
    v_exp_f32 v55, v55
    v_mfma_f32_16x16x32_bf16 v[148:151], a[180:183], v[36:39], v[148:151]
    v_fma_f32 v56, v56, s35, v84
    v_fma_f32 v57, v57, s35, v84
    v_mfma_f32_16x16x32_bf16 v[152:155], a[184:187], v[36:39], v[152:155]
    v_exp_f32 v56, v56
    v_mfma_f32_16x16x32_bf16 v[184:187], a[184:187], v[44:47], v[184:187]
    v_exp_f32 v57, v57
    v_mfma_f32_16x16x32_bf16 v[188:191], a[188:191], v[44:47], v[188:191]
    v_cvt_pk_bf16_f32 v52, v52, v53
    v_fma_f32 v58, v58, s35, v84
    v_mfma_f32_16x16x32_bf16 v[156:159], a[188:191], v[36:39], v[156:159]
    s_waitcnt lgkmcnt(0)
    v_fma_f32 v59, v59, s35, v84
    v_mfma_f32_16x16x32_bf16 v[36:39], a[128:131], a[96:99], 0
    v_exp_f32 v58, v58
    v_mfma_f32_16x16x32_bf16 v[36:39], a[132:135], a[100:103], v[36:39]
    v_exp_f32 v59, v59
    v_mfma_f32_16x16x32_bf16 v[36:39], a[136:139], a[104:107], v[36:39]
    v_cvt_pk_bf16_f32 v53, v54, v55
    v_cvt_pk_bf16_f32 v54, v56, v57
    v_mfma_f32_16x16x32_bf16 v[36:39], a[140:143], a[108:111], v[36:39]
    v_cvt_pk_bf16_f32 v55, v58, v59
    v_fma_f32 v60, v60, s35, v88
    v_mfma_f32_16x16x32_bf16 v[40:43], a[144:147], a[96:99], 0
    v_exp_f32 v60, v60
    v_pk_mul_f32 v[128:129], v[128:129], v[76:77] op_sel:[0,1] op_sel_hi:[1,1]
    v_pk_mul_f32 v[130:131], v[130:131], v[76:77] op_sel:[0,1] op_sel_hi:[1,1]
    v_cvt_pk_bf16_f32 v128, v128, v129
    v_cvt_pk_bf16_f32 v129, v130, v131
    ds_write_b64 v8, v[128:129] offset:0
    v_pk_mul_f32 v[132:133], v[132:133], v[76:77] op_sel:[0,1] op_sel_hi:[1,1]
    v_pk_mul_f32 v[134:135], v[134:135], v[76:77] op_sel:[0,1] op_sel_hi:[1,1]
    v_cvt_pk_bf16_f32 v132, v132, v133
    v_cvt_pk_bf16_f32 v133, v134, v135
    ds_write_b64 v8, v[132:133] offset:32
    v_pk_mul_f32 v[136:137], v[136:137], v[76:77] op_sel:[0,1] op_sel_hi:[1,1]
    v_pk_mul_f32 v[138:139], v[138:139], v[76:77] op_sel:[0,1] op_sel_hi:[1,1]
    v_cvt_pk_bf16_f32 v136, v136, v137
    v_cvt_pk_bf16_f32 v137, v138, v139
    ds_write_b64 v8, v[136:137] offset:64
    v_pk_mul_f32 v[140:141], v[140:141], v[76:77] op_sel:[0,1] op_sel_hi:[1,1]
    v_pk_mul_f32 v[142:143], v[142:143], v[76:77] op_sel:[0,1] op_sel_hi:[1,1]
    v_cvt_pk_bf16_f32 v140, v140, v141
    v_cvt_pk_bf16_f32 v141, v142, v143
    ds_write_b64 v8, v[140:141] offset:96
    v_pk_mul_f32 v[144:145], v[144:145], v[76:77] op_sel:[0,1] op_sel_hi:[1,1]
    v_pk_mul_f32 v[146:147], v[146:147], v[76:77] op_sel:[0,1] op_sel_hi:[1,1]
    v_cvt_pk_bf16_f32 v144, v144, v145
    v_cvt_pk_bf16_f32 v145, v146, v147
    ds_write_b64 v8, v[144:145] offset:128
    v_pk_mul_f32 v[148:149], v[148:149], v[76:77] op_sel:[0,1] op_sel_hi:[1,1]
    v_pk_mul_f32 v[150:151], v[150:151], v[76:77] op_sel:[0,1] op_sel_hi:[1,1]
    v_cvt_pk_bf16_f32 v148, v148, v149
    v_cvt_pk_bf16_f32 v149, v150, v151
    ds_write_b64 v8, v[148:149] offset:160
    v_pk_mul_f32 v[152:153], v[152:153], v[76:77] op_sel:[0,1] op_sel_hi:[1,1]
    v_pk_mul_f32 v[154:155], v[154:155], v[76:77] op_sel:[0,1] op_sel_hi:[1,1]
    v_cvt_pk_bf16_f32 v152, v152, v153
    v_cvt_pk_bf16_f32 v153, v154, v155
    ds_write_b64 v8, v[152:153] offset:192
    v_pk_mul_f32 v[156:157], v[156:157], v[76:77] op_sel:[0,1] op_sel_hi:[1,1]
    v_pk_mul_f32 v[158:159], v[158:159], v[76:77] op_sel:[0,1] op_sel_hi:[1,1]
    v_cvt_pk_bf16_f32 v156, v156, v157
    v_cvt_pk_bf16_f32 v157, v158, v159
    ds_write_b64 v8, v[156:157] offset:224
    v_mfma_f32_16x16x32_bf16 v[40:43], a[148:151], a[100:103], v[40:43]
    ds_read_b128 v[128:131], v6 offset:0
    ds_read_b128 v[132:135], v6 offset:1088
    v_mfma_f32_16x16x32_bf16 v[40:43], a[152:155], a[104:107], v[40:43]
    ds_read_b128 v[136:139], v6 offset:2176
    ds_read_b128 v[140:143], v6 offset:3264
    v_mfma_f32_16x16x32_bf16 v[40:43], a[156:159], a[108:111], v[40:43]
    v_fma_f32 v61, v61, s35, v88
    v_fma_f32 v62, v62, s35, v88
    v_mfma_f32_16x16x32_bf16 v[44:47], a[128:131], a[112:115], 0
    ds_read_b128 a[128:131], v9 offset:24576
    v_fma_f32 v63, v63, s35, v88
    v_mfma_f32_16x16x32_bf16 v[44:47], a[132:135], a[116:119], v[44:47]
    v_exp_f32 v61, v61
    v_mfma_f32_16x16x32_bf16 v[44:47], a[136:139], a[120:123], v[44:47]
    ds_read_b128 a[132:135], v10 offset:24576
    v_fma_f32 v64, v64, s35, v88
    v_mfma_f32_16x16x32_bf16 v[44:47], a[140:143], a[124:127], v[44:47]
    v_exp_f32 v62, v62
    v_mfma_f32_16x16x32_bf16 v[48:51], a[144:147], a[112:115], 0
    v_exp_f32 v63, v63
    v_mfma_f32_16x16x32_bf16 v[48:51], a[148:151], a[116:119], v[48:51]
    ds_read_b128 a[136:139], v11 offset:24576
    v_fma_f32 v65, v65, s35, v88
    v_mfma_f32_16x16x32_bf16 v[48:51], a[152:155], a[120:123], v[48:51]
    v_exp_f32 v64, v64
    v_mfma_f32_16x16x32_bf16 v[48:51], a[156:159], a[124:127], v[48:51]
    v_cvt_pk_bf16_f32 v60, v60, v61
    v_fma_f32 v66, v66, s35, v88
    v_mfma_f32_16x16x32_bf16 a[208:211], a[216:219], v[52:55], a[208:211]
    ds_read_b128 a[140:143], v12 offset:24576
    v_fma_f32 v67, v67, s35, v88
    v_cvt_pk_bf16_f32 v61, v62, v63
    v_exp_f32 v65, v65
    v_exp_f32 v66, v66
    v_cvt_pk_bf16_f32 v62, v64, v65
    v_exp_f32 v67, v67
    v_fma_f32 v36, v36, s35, v84
    v_cvt_pk_bf16_f32 v63, v66, v67
    v_fma_f32 v37, v37, s35, v84
    v_fma_f32 v38, v38, s35, v84
    v_mfma_f32_16x16x32_bf16 a[212:215], a[216:219], v[60:63], a[212:215]
    s_waitcnt lgkmcnt(7)
    buffer_store_dwordx4 v[128:131], v1, s[24:27], s58 offen offset:0 nt
    v_mfma_f32_16x16x32_bf16 v[192:195], a[160:163], v[52:55], v[192:195]
    ds_read_b128 a[144:147], v9 offset:28672
    v_fma_f32 v39, v39, s35, v84
    v_mfma_f32_16x16x32_bf16 v[224:227], a[160:163], v[60:63], v[224:227]
    ds_read_b64_tr_b16 a[160:161], v13 offset:16384
    v_fma_f32 v40, v40, s35, v84
    v_mfma_f32_16x16x32_bf16 v[228:231], a[164:167], v[60:63], v[228:231]
    ds_read_b64_tr_b16 a[162:163], v13 offset:20480
    v_fma_f32 v41, v41, s35, v84
    v_mfma_f32_16x16x32_bf16 v[196:199], a[164:167], v[52:55], v[196:199]
    ds_read_b128 a[148:151], v10 offset:28672
    v_fma_f32 v42, v42, s35, v84
    v_mfma_f32_16x16x32_bf16 v[200:203], a[168:171], v[52:55], v[200:203]
    ds_read_b64_tr_b16 a[164:165], v14 offset:16384
    v_fma_f32 v43, v43, s35, v84
    v_mfma_f32_16x16x32_bf16 v[232:235], a[168:171], v[60:63], v[232:235]
    s_waitcnt lgkmcnt(11)
    buffer_store_dwordx4 v[132:135], v1, s[24:27], s58 offen offset:1024 nt
    v_mfma_f32_16x16x32_bf16 v[236:239], a[172:175], v[60:63], v[236:239]
    ds_read_b64_tr_b16 a[166:167], v14 offset:20480
    ds_read_b128 a[152:155], v11 offset:28672
    v_pk_mul_f32 v[160:161], v[160:161], v[80:81] op_sel:[0,1] op_sel_hi:[1,1]
    v_pk_mul_f32 v[162:163], v[162:163], v[80:81] op_sel:[0,1] op_sel_hi:[1,1]
    v_cvt_pk_bf16_f32 v160, v160, v161
    v_cvt_pk_bf16_f32 v161, v162, v163
    ds_write_b64 v8, v[160:161] offset:4352
    v_pk_mul_f32 v[164:165], v[164:165], v[80:81] op_sel:[0,1] op_sel_hi:[1,1]
    v_pk_mul_f32 v[166:167], v[166:167], v[80:81] op_sel:[0,1] op_sel_hi:[1,1]
    v_cvt_pk_bf16_f32 v164, v164, v165
    v_cvt_pk_bf16_f32 v165, v166, v167
    ds_write_b64 v8, v[164:165] offset:4384
    v_pk_mul_f32 v[168:169], v[168:169], v[80:81] op_sel:[0,1] op_sel_hi:[1,1]
    v_pk_mul_f32 v[170:171], v[170:171], v[80:81] op_sel:[0,1] op_sel_hi:[1,1]
    v_cvt_pk_bf16_f32 v168, v168, v169
    v_cvt_pk_bf16_f32 v169, v170, v171
    ds_write_b64 v8, v[168:169] offset:4416
    v_pk_mul_f32 v[172:173], v[172:173], v[80:81] op_sel:[0,1] op_sel_hi:[1,1]
    v_pk_mul_f32 v[174:175], v[174:175], v[80:81] op_sel:[0,1] op_sel_hi:[1,1]
    v_cvt_pk_bf16_f32 v172, v172, v173
    v_cvt_pk_bf16_f32 v173, v174, v175
    ds_write_b64 v8, v[172:173] offset:4448
    v_pk_mul_f32 v[176:177], v[176:177], v[80:81] op_sel:[0,1] op_sel_hi:[1,1]
    v_pk_mul_f32 v[178:179], v[178:179], v[80:81] op_sel:[0,1] op_sel_hi:[1,1]
    v_cvt_pk_bf16_f32 v176, v176, v177
    v_cvt_pk_bf16_f32 v177, v178, v179
    ds_write_b64 v8, v[176:177] offset:4480
    v_pk_mul_f32 v[180:181], v[180:181], v[80:81] op_sel:[0,1] op_sel_hi:[1,1]
    v_pk_mul_f32 v[182:183], v[182:183], v[80:81] op_sel:[0,1] op_sel_hi:[1,1]
    v_cvt_pk_bf16_f32 v180, v180, v181
    v_cvt_pk_bf16_f32 v181, v182, v183
    ds_write_b64 v8, v[180:181] offset:4512
    v_pk_mul_f32 v[184:185], v[184:185], v[80:81] op_sel:[0,1] op_sel_hi:[1,1]
    v_pk_mul_f32 v[186:187], v[186:187], v[80:81] op_sel:[0,1] op_sel_hi:[1,1]
    v_cvt_pk_bf16_f32 v184, v184, v185
    v_cvt_pk_bf16_f32 v185, v186, v187
    ds_write_b64 v8, v[184:185] offset:4544
    v_pk_mul_f32 v[188:189], v[188:189], v[80:81] op_sel:[0,1] op_sel_hi:[1,1]
    v_pk_mul_f32 v[190:191], v[190:191], v[80:81] op_sel:[0,1] op_sel_hi:[1,1]
    v_cvt_pk_bf16_f32 v188, v188, v189
    v_cvt_pk_bf16_f32 v189, v190, v191
    ds_write_b64 v8, v[188:189] offset:4576
    v_mfma_f32_16x16x32_bf16 v[204:207], a[172:175], v[52:55], v[204:207]
    ds_read_b128 v[160:163], v6 offset:4352
    ds_read_b128 v[164:167], v6 offset:5440
    v_mfma_f32_16x16x32_bf16 v[208:211], a[176:179], v[52:55], v[208:211]
    ds_read_b64_tr_b16 a[168:169], v15 offset:16384
    ds_read_b128 v[168:171], v6 offset:6528
    v_mfma_f32_16x16x32_bf16 v[240:243], a[176:179], v[60:63], v[240:243]
    ds_read_b128 a[156:159], v12 offset:28672
    ds_read_b128 v[172:175], v6 offset:7616
    v_mfma_f32_16x16x32_bf16 v[244:247], a[180:183], v[60:63], v[244:247]
    ds_read_b64_tr_b16 a[170:171], v15 offset:20480
    v_fma_f32 v44, v44, s35, v88
    v_mfma_f32_16x16x32_bf16 v[212:215], a[180:183], v[52:55], v[212:215]
    ds_read_b64_tr_b16 a[172:173], v16 offset:16384
    v_fma_f32 v45, v45, s35, v88
    v_mfma_f32_16x16x32_bf16 v[216:219], a[184:187], v[52:55], v[216:219]
    s_waitcnt lgkmcnt(15)
    buffer_store_dwordx4 v[136:139], v1, s[24:27], s58 offen offset:2048 nt
    v_mfma_f32_16x16x32_bf16 v[248:251], a[184:187], v[60:63], v[248:251]
    ds_read_b64_tr_b16 a[174:175], v16 offset:20480
    v_fma_f32 v46, v46, s35, v88
    v_mfma_f32_16x16x32_bf16 v[252:255], a[188:191], v[60:63], v[252:255]
    v_exp_f32 v36, v36
    v_mfma_f32_16x16x32_bf16 v[220:223], a[188:191], v[52:55], v[220:223]
    ds_read_b64_tr_b16 a[176:177], v17 offset:16384
    s_waitcnt lgkmcnt(5)
    v_mfma_f32_16x16x32_bf16 v[52:55], a[128:131], a[96:99], 0
    v_exp_f32 v37, v37
    v_mfma_f32_16x16x32_bf16 v[52:55], a[132:135], a[100:103], v[52:55]
    ds_read_b64_tr_b16 a[178:179], v17 offset:20480
    v_cvt_pk_bf16_f32 v36, v36, v37
    v_mfma_f32_16x16x32_bf16 v[52:55], a[136:139], a[104:107], v[52:55]
    buffer_store_dwordx4 v[140:143], v1, s[24:27], s58 offen offset:3072 nt
    v_mfma_f32_16x16x32_bf16 v[52:55], a[140:143], a[108:111], v[52:55]
    ds_read_b64_tr_b16 a[180:181], v18 offset:16384
    v_fma_f32 v47, v47, s35, v88
    v_mfma_f32_16x16x32_bf16 v[56:59], a[144:147], a[96:99], 0
    ds_read_b64_tr_b16 a[182:183], v18 offset:20480
    v_fma_f32 v48, v48, s35, v88
    v_mfma_f32_16x16x32_bf16 v[56:59], a[148:151], a[100:103], v[56:59]
    v_exp_f32 v38, v38
    v_mfma_f32_16x16x32_bf16 v[56:59], a[152:155], a[104:107], v[56:59]
    ds_read_b64_tr_b16 a[184:185], v19 offset:16384
    v_fma_f32 v49, v49, s35, v88
    v_mfma_f32_16x16x32_bf16 v[56:59], a[156:159], a[108:111], v[56:59]
    buffer_store_dwordx4 v[160:163], v1, s[24:27], s59 offen offset:0 nt
    v_mfma_f32_16x16x32_bf16 v[60:63], a[128:131], a[112:115], 0
    ds_read_b64_tr_b16 a[186:187], v19 offset:20480
    v_fma_f32 v50, v50, s35, v88
    v_mfma_f32_16x16x32_bf16 v[60:63], a[132:135], a[116:119], v[60:63]
    v_exp_f32 v39, v39
    v_mfma_f32_16x16x32_bf16 v[60:63], a[136:139], a[120:123], v[60:63]
    ds_read_b64_tr_b16 a[188:189], v20 offset:16384
    v_cvt_pk_bf16_f32 v37, v38, v39
    v_mfma_f32_16x16x32_bf16 v[60:63], a[140:143], a[124:127], v[60:63]
    v_exp_f32 v40, v40
    v_mfma_f32_16x16x32_bf16 v[64:67], a[144:147], a[112:115], 0
    ds_read_b64_tr_b16 a[190:191], v20 offset:20480
    v_fma_f32 v51, v51, s35, v88
    v_mfma_f32_16x16x32_bf16 v[64:67], a[148:151], a[116:119], v[64:67]
    buffer_store_dwordx4 v[164:167], v1, s[24:27], s59 offen offset:1024 nt
    v_mfma_f32_16x16x32_bf16 v[64:67], a[152:155], a[120:123], v[64:67]
    v_exp_f32 v41, v41
    v_mfma_f32_16x16x32_bf16 v[64:67], a[156:159], a[124:127], v[64:67]
    v_cvt_pk_bf16_f32 v38, v40, v41
    v_fma_f32 v52, v52, s35, v84
    v_exp_f32 v42, v42
    v_exp_f32 v43, v43
    v_fma_f32 v53, v53, s35, v84
    v_cvt_pk_bf16_f32 v39, v42, v43
    v_fma_f32 v54, v54, s35, v84
    v_fma_f32 v55, v55, s35, v84
    v_mfma_f32_16x16x32_bf16 a[208:211], a[216:219], v[36:39], a[208:211]
    v_exp_f32 v44, v44
    v_exp_f32 v45, v45
    v_exp_f32 v46, v46
    v_cvt_pk_bf16_f32 v44, v44, v45
    v_exp_f32 v47, v47
    v_exp_f32 v48, v48
    v_cvt_pk_bf16_f32 v45, v46, v47
    v_exp_f32 v49, v49
    v_exp_f32 v50, v50
    v_cvt_pk_bf16_f32 v46, v48, v49
    v_exp_f32 v51, v51
    v_fma_f32 v56, v56, s35, v84
    v_cvt_pk_bf16_f32 v47, v50, v51
    v_fma_f32 v57, v57, s35, v84
    v_fma_f32 v58, v58, s35, v84
    v_mfma_f32_16x16x32_bf16 a[212:215], a[216:219], v[44:47], a[212:215]
    s_waitcnt lgkmcnt(0)
    v_fma_f32 v59, v59, s35, v84
    v_mfma_f32_16x16x32_bf16 v[192:195], a[160:163], v[36:39], v[192:195]
    buffer_store_dwordx4 v[168:171], v1, s[24:27], s59 offen offset:2048 nt
    v_mfma_f32_16x16x32_bf16 v[224:227], a[160:163], v[44:47], v[224:227]
    ds_read_b64_tr_b16 a[160:161], v13 offset:24576
    ds_read_b64_tr_b16 a[162:163], v13 offset:28672
    v_mfma_f32_16x16x32_bf16 v[228:231], a[164:167], v[44:47], v[228:231]
    v_exp_f32 v52, v52
    v_mfma_f32_16x16x32_bf16 v[196:199], a[164:167], v[36:39], v[196:199]
    ds_read_b64_tr_b16 a[164:165], v14 offset:24576
    ds_read_b64_tr_b16 a[166:167], v14 offset:28672
    v_mfma_f32_16x16x32_bf16 v[200:203], a[168:171], v[36:39], v[200:203]
    v_exp_f32 v53, v53
    v_mfma_f32_16x16x32_bf16 v[232:235], a[168:171], v[44:47], v[232:235]
    ds_read_b64_tr_b16 a[168:169], v15 offset:24576
    ds_read_b64_tr_b16 a[170:171], v15 offset:28672
    v_mfma_f32_16x16x32_bf16 v[236:239], a[172:175], v[44:47], v[236:239]
    buffer_store_dwordx4 v[172:175], v1, s[24:27], s59 offen offset:3072 nt
    v_mfma_f32_16x16x32_bf16 v[204:207], a[172:175], v[36:39], v[204:207]
    ds_read_b64_tr_b16 a[172:173], v16 offset:24576
    ds_read_b64_tr_b16 a[174:175], v16 offset:28672
    v_mfma_f32_16x16x32_bf16 v[208:211], a[176:179], v[36:39], v[208:211]
    v_exp_f32 v54, v54
    v_mfma_f32_16x16x32_bf16 v[240:243], a[176:179], v[44:47], v[240:243]
    ds_read_b64_tr_b16 a[176:177], v17 offset:24576
    ds_read_b64_tr_b16 a[178:179], v17 offset:28672
    v_mfma_f32_16x16x32_bf16 v[244:247], a[180:183], v[44:47], v[244:247]
    v_exp_f32 v55, v55
    v_mfma_f32_16x16x32_bf16 v[212:215], a[180:183], v[36:39], v[212:215]
    ds_read_b64_tr_b16 a[180:181], v18 offset:24576
    ds_read_b64_tr_b16 a[182:183], v18 offset:28672
    v_mfma_f32_16x16x32_bf16 v[216:219], a[184:187], v[36:39], v[216:219]
    v_exp_f32 v56, v56
    v_mfma_f32_16x16x32_bf16 v[248:251], a[184:187], v[44:47], v[248:251]
    ds_read_b64_tr_b16 a[184:185], v19 offset:24576
    ds_read_b64_tr_b16 a[186:187], v19 offset:28672
    v_mfma_f32_16x16x32_bf16 v[252:255], a[188:191], v[44:47], v[252:255]
    v_cvt_pk_bf16_f32 v52, v52, v53
    v_cvt_pk_bf16_f32 v53, v54, v55
    v_mfma_f32_16x16x32_bf16 v[220:223], a[188:191], v[36:39], v[220:223]
    ds_read_b64_tr_b16 a[188:189], v20 offset:24576
    ds_read_b64_tr_b16 a[190:191], v20 offset:28672
    v_exp_f32 v57, v57
    v_exp_f32 v58, v58
    v_cvt_pk_bf16_f32 v54, v56, v57
    v_exp_f32 v59, v59
    v_fma_f32 v60, v60, s35, v88
    v_cvt_pk_bf16_f32 v55, v58, v59
    v_fma_f32 v61, v61, s35, v88
    v_fma_f32 v62, v62, s35, v88
    v_mfma_f32_16x16x32_bf16 a[208:211], a[216:219], v[52:55], a[208:211]
    v_fma_f32 v63, v63, s35, v88
    v_fma_f32 v64, v64, s35, v88
    v_exp_f32 v60, v60
    v_exp_f32 v61, v61
    v_fma_f32 v65, v65, s35, v88
    v_cvt_pk_bf16_f32 v60, v60, v61
    v_exp_f32 v62, v62
    v_exp_f32 v63, v63
    v_fma_f32 v66, v66, s35, v88
    v_fma_f32 v67, v67, s35, v88
    v_cvt_pk_bf16_f32 v61, v62, v63
    v_exp_f32 v64, v64
    v_exp_f32 v65, v65
    v_exp_f32 v66, v66
    v_cvt_pk_bf16_f32 v62, v64, v65
    v_exp_f32 v67, v67
    v_accvgpr_read_b32 v86, a208
    v_cvt_pk_bf16_f32 v63, v66, v67
    s_nop 1
    v_mfma_f32_16x16x32_bf16 a[212:215], a[216:219], v[60:63], a[212:215]
    v_rcp_f32 v85, v86
    s_waitcnt lgkmcnt(14)
    v_mfma_f32_16x16x32_bf16 v[192:195], a[160:163], v[52:55], v[192:195]
    v_cmp_nge_f32 s[70:71], s3, v86
    v_mfma_f32_16x16x32_bf16 v[224:227], a[160:163], v[60:63], v[224:227]
    s_waitcnt lgkmcnt(12)
    v_mfma_f32_16x16x32_bf16 v[228:231], a[164:167], v[60:63], v[228:231]
    v_mfma_f32_16x16x32_bf16 v[196:199], a[164:167], v[52:55], v[196:199]
    v_accvgpr_read_b32 v90, a212
    s_waitcnt lgkmcnt(10)
    v_mfma_f32_16x16x32_bf16 v[200:203], a[168:171], v[52:55], v[200:203]
    v_rcp_f32 v89, v90
    v_mfma_f32_16x16x32_bf16 v[232:235], a[168:171], v[60:63], v[232:235]
    v_mul_f32 v192, v85, v192
    v_mul_f32 v193, v85, v193
    s_waitcnt lgkmcnt(8)
    v_mfma_f32_16x16x32_bf16 v[236:239], a[172:175], v[60:63], v[236:239]
    v_mul_f32 v194, v85, v194
    v_mul_f32 v195, v85, v195
    v_mfma_f32_16x16x32_bf16 v[204:207], a[172:175], v[52:55], v[204:207]
    v_cvt_pk_bf16_f32 v192, v192, v193
    v_cvt_pk_bf16_f32 v193, v194, v195
    s_waitcnt lgkmcnt(6)
    v_mfma_f32_16x16x32_bf16 v[208:211], a[176:179], v[52:55], v[208:211]
    ds_write_b64 v8, v[192:193] offset:0
    v_mfma_f32_16x16x32_bf16 v[240:243], a[176:179], v[60:63], v[240:243]
    v_mul_f32 v196, v85, v196
    v_mul_f32 v197, v85, v197
    s_waitcnt lgkmcnt(5)
    v_mfma_f32_16x16x32_bf16 v[244:247], a[180:183], v[60:63], v[244:247]
    v_mul_f32 v198, v85, v198
    v_mul_f32 v199, v85, v199
    v_mfma_f32_16x16x32_bf16 v[212:215], a[180:183], v[52:55], v[212:215]
    v_cvt_pk_bf16_f32 v196, v196, v197
    v_cvt_pk_bf16_f32 v197, v198, v199
    s_waitcnt lgkmcnt(3)
    v_mfma_f32_16x16x32_bf16 v[216:219], a[184:187], v[52:55], v[216:219]
    ds_write_b64 v8, v[196:197] offset:32
    v_mfma_f32_16x16x32_bf16 v[248:251], a[184:187], v[60:63], v[248:251]
    v_mul_f32 v200, v85, v200
    v_mul_f32 v201, v85, v201
    s_waitcnt lgkmcnt(2)
    v_mfma_f32_16x16x32_bf16 v[252:255], a[188:191], v[60:63], v[252:255]
    v_mul_f32 v202, v85, v202
    v_mul_f32 v203, v85, v203
    v_mfma_f32_16x16x32_bf16 v[220:223], a[188:191], v[52:55], v[220:223]
    v_cvt_pk_bf16_f32 v200, v200, v201
    v_cvt_pk_bf16_f32 v201, v202, v203
    ds_write_b64 v8, v[200:201] offset:64
    v_pk_mul_f32 v[204:205], v[204:205], v[84:85] op_sel:[0,1] op_sel_hi:[1,1]
    v_pk_mul_f32 v[206:207], v[206:207], v[84:85] op_sel:[0,1] op_sel_hi:[1,1]
    v_cvt_pk_bf16_f32 v204, v204, v205
    v_cvt_pk_bf16_f32 v205, v206, v207
    ds_write_b64 v8, v[204:205] offset:96
    v_pk_mul_f32 v[208:209], v[208:209], v[84:85] op_sel:[0,1] op_sel_hi:[1,1]
    v_pk_mul_f32 v[210:211], v[210:211], v[84:85] op_sel:[0,1] op_sel_hi:[1,1]
    v_cvt_pk_bf16_f32 v208, v208, v209
    v_cvt_pk_bf16_f32 v209, v210, v211
    ds_write_b64 v8, v[208:209] offset:128
    v_pk_mul_f32 v[212:213], v[212:213], v[84:85] op_sel:[0,1] op_sel_hi:[1,1]
    v_pk_mul_f32 v[214:215], v[214:215], v[84:85] op_sel:[0,1] op_sel_hi:[1,1]
    v_cvt_pk_bf16_f32 v212, v212, v213
    v_cvt_pk_bf16_f32 v213, v214, v215
    ds_write_b64 v8, v[212:213] offset:160
    v_pk_mul_f32 v[216:217], v[216:217], v[84:85] op_sel:[0,1] op_sel_hi:[1,1]
    v_pk_mul_f32 v[218:219], v[218:219], v[84:85] op_sel:[0,1] op_sel_hi:[1,1]
    v_cvt_pk_bf16_f32 v216, v216, v217
    v_cvt_pk_bf16_f32 v217, v218, v219
    ds_write_b64 v8, v[216:217] offset:192
    v_pk_mul_f32 v[220:221], v[220:221], v[84:85] op_sel:[0,1] op_sel_hi:[1,1]
    v_pk_mul_f32 v[222:223], v[222:223], v[84:85] op_sel:[0,1] op_sel_hi:[1,1]
    v_cvt_pk_bf16_f32 v220, v220, v221
    v_cvt_pk_bf16_f32 v221, v222, v223
    ds_write_b64 v8, v[220:221] offset:224
    ds_read_b128 v[192:195], v6 offset:0
    ds_read_b128 v[196:199], v6 offset:1088
    ds_read_b128 v[200:203], v6 offset:2176
    ds_read_b128 v[204:207], v6 offset:3264
    v_cmp_nge_f32 s[72:73], s3, v90
    v_mul_f32 v224, v89, v224
    v_mul_f32 v225, v89, v225
    v_mul_f32 v226, v89, v226
    v_mul_f32 v227, v89, v227
    v_cvt_pk_bf16_f32 v224, v224, v225
    v_cvt_pk_bf16_f32 v225, v226, v227
    ds_write_b64 v8, v[224:225] offset:4352
    v_mul_f32 v228, v89, v228
    v_mul_f32 v229, v89, v229
    v_mul_f32 v230, v89, v230
    v_mul_f32 v231, v89, v231
    v_cvt_pk_bf16_f32 v228, v228, v229
    v_cvt_pk_bf16_f32 v229, v230, v231
    ds_write_b64 v8, v[228:229] offset:4384
    v_mul_f32 v232, v89, v232
    v_mul_f32 v233, v89, v233
    v_mul_f32 v234, v89, v234
    v_mul_f32 v235, v89, v235
    v_cvt_pk_bf16_f32 v232, v232, v233
    v_cvt_pk_bf16_f32 v233, v234, v235
    ds_write_b64 v8, v[232:233] offset:4416
    s_waitcnt lgkmcnt(6)
    buffer_store_dwordx4 v[192:195], v1, s[24:27], s60 offen offset:0 nt
    v_pk_mul_f32 v[236:237], v[236:237], v[88:89] op_sel:[0,1] op_sel_hi:[1,1]
    v_pk_mul_f32 v[238:239], v[238:239], v[88:89] op_sel:[0,1] op_sel_hi:[1,1]
    v_cvt_pk_bf16_f32 v236, v236, v237
    v_cvt_pk_bf16_f32 v237, v238, v239
    ds_write_b64 v8, v[236:237] offset:4448
    v_pk_mul_f32 v[240:241], v[240:241], v[88:89] op_sel:[0,1] op_sel_hi:[1,1]
    v_pk_mul_f32 v[242:243], v[242:243], v[88:89] op_sel:[0,1] op_sel_hi:[1,1]
    s_waitcnt lgkmcnt(6)
    buffer_store_dwordx4 v[196:199], v1, s[24:27], s60 offen offset:1024 nt
    v_cvt_pk_bf16_f32 v240, v240, v241
    v_cvt_pk_bf16_f32 v241, v242, v243
    ds_write_b64 v8, v[240:241] offset:4480
    v_pk_mul_f32 v[244:245], v[244:245], v[88:89] op_sel:[0,1] op_sel_hi:[1,1]
    v_pk_mul_f32 v[246:247], v[246:247], v[88:89] op_sel:[0,1] op_sel_hi:[1,1]
    v_cvt_pk_bf16_f32 v244, v244, v245
    v_cvt_pk_bf16_f32 v245, v246, v247
    s_waitcnt lgkmcnt(6)
    buffer_store_dwordx4 v[200:203], v1, s[24:27], s60 offen offset:2048 nt
    ds_write_b64 v8, v[244:245] offset:4512
    v_pk_mul_f32 v[248:249], v[248:249], v[88:89] op_sel:[0,1] op_sel_hi:[1,1]
    v_pk_mul_f32 v[250:251], v[250:251], v[88:89] op_sel:[0,1] op_sel_hi:[1,1]
    v_cvt_pk_bf16_f32 v248, v248, v249
    v_cvt_pk_bf16_f32 v249, v250, v251
    ds_write_b64 v8, v[248:249] offset:4544
    v_pk_mul_f32 v[252:253], v[252:253], v[88:89] op_sel:[0,1] op_sel_hi:[1,1]
    s_waitcnt lgkmcnt(7)
    buffer_store_dwordx4 v[204:207], v1, s[24:27], s60 offen offset:3072 nt
    v_pk_mul_f32 v[254:255], v[254:255], v[88:89] op_sel:[0,1] op_sel_hi:[1,1]
    v_cvt_pk_bf16_f32 v252, v252, v253
    v_cvt_pk_bf16_f32 v253, v254, v255
    ds_write_b64 v8, v[252:253] offset:4576
    ds_read_b128 v[224:227], v6 offset:4352
    ds_read_b128 v[228:231], v6 offset:5440
    ds_read_b128 v[232:235], v6 offset:6528
    ds_read_b128 v[236:239], v6 offset:7616
    s_waitcnt lgkmcnt(3)
    buffer_store_dwordx4 v[224:227], v1, s[24:27], s61 offen offset:0 nt
    s_waitcnt lgkmcnt(2)
    buffer_store_dwordx4 v[228:231], v1, s[24:27], s61 offen offset:1024 nt
    s_waitcnt lgkmcnt(1)
    buffer_store_dwordx4 v[232:235], v1, s[24:27], s61 offen offset:2048 nt
    s_waitcnt lgkmcnt(0)
    buffer_store_dwordx4 v[236:239], v1, s[24:27], s61 offen offset:3072 nt
    s_or_b64 s[74:75], s[62:63], s[64:65]
    s_or_b64 s[74:75], s[74:75], s[66:67]
    s_or_b64 s[74:75], s[74:75], s[68:69]
    s_or_b64 s[74:75], s[74:75], s[70:71]
    s_or_b64 s[74:75], s[74:75], s[72:73]
    s_cbranch_scc1 Lslow
Lend:
    s_endpgm
Lslow:
    s_waitcnt vmcnt(0) lgkmcnt(0)
    s_nop 7
    s_nop 7
    v_lshrrev_b32 v95, 4, v1
    v_and_b32 v92, 15, v95
    v_lshlrev_b32 v92, 8, v92
    v_lshrrev_b32 v95, 4, v95
    v_lshl_add_u32 v92, v95, 4, v92
    v_subrev_u32 v93, s33, v4
    v_subrev_u32 v94, s33, v5
    s_sub_u32 s77, s39, 49152
    v_add_u32 v13, s77, v13
    v_add_u32 v14, s77, v14
    v_add_u32 v15, s77, v15
    v_add_u32 v16, s77, v16
    v_add_u32 v17, s77, v17
    v_add_u32 v18, s77, v18
    v_add_u32 v19, s77, v19
    v_add_u32 v20, s77, v20
    s_mov_b32 s74, 0
    s_mov_b32 s75, s56
Lslow_tile:
    s_cmp_eq_u64 s[62:63], 0
    s_cbranch_scc1 Lslow_next
    buffer_load_dwordx4 v[96:99], v1, s[12:15], s75 offen offset:0
    buffer_load_dwordx4 v[100:103], v1, s[12:15], s75 offen offset:1024
    buffer_load_dwordx4 v[104:107], v1, s[12:15], s75 offen offset:2048
    buffer_load_dwordx4 v[108:111], v1, s[12:15], s75 offen offset:3072
    s_waitcnt vmcnt(3)
    v_lshlrev_b32 v22, 16, v96
    v_and_b32 v23, s36, v96
    v_mul_f32 v22, s35, v22
    v_mul_f32 v23, s35, v23
    v_cvt_pk_bf16_f32 v96, v22, v23
    v_lshlrev_b32 v24, 16, v97
    v_and_b32 v25, s36, v97
    v_mul_f32 v24, s35, v24
    v_mul_f32 v25, s35, v25
    v_cvt_pk_bf16_f32 v97, v24, v25
    ds_write_b64 v6, v[96:97] offset:0
    v_lshlrev_b32 v22, 16, v98
    v_and_b32 v23, s36, v98
    v_mul_f32 v22, s35, v22
    v_mul_f32 v23, s35, v23
    v_cvt_pk_bf16_f32 v98, v22, v23
    v_lshlrev_b32 v24, 16, v99
    v_and_b32 v25, s36, v99
    v_mul_f32 v24, s35, v24
    v_mul_f32 v25, s35, v25
    v_cvt_pk_bf16_f32 v99, v24, v25
    ds_write_b64 v6, v[98:99] offset:8
    s_waitcnt vmcnt(2)
    v_lshlrev_b32 v22, 16, v100
    v_and_b32 v23, s36, v100
    v_mul_f32 v22, s35, v22
    v_mul_f32 v23, s35, v23
    v_cvt_pk_bf16_f32 v100, v22, v23
    v_lshlrev_b32 v24, 16, v101
    v_and_b32 v25, s36, v101
    v_mul_f32 v24, s35, v24
    v_mul_f32 v25, s35, v25
    v_cvt_pk_bf16_f32 v101, v24, v25
    ds_write_b64 v6, v[100:101] offset:1088
    v_lshlrev_b32 v22, 16, v102
    v_and_b32 v23, s36, v102
    v_mul_f32 v22, s35, v22
    v_mul_f32 v23, s35, v23
    v_cvt_pk_bf16_f32 v102, v22, v23
    v_lshlrev_b32 v24, 16, v103
    v_and_b32 v25, s36, v103
    v_mul_f32 v24, s35, v24
    v_mul_f32 v25, s35, v25
    v_cvt_pk_bf16_f32 v103, v24, v25
    ds_write_b64 v6, v[102:103] offset:1096
    s_waitcnt vmcnt(1)
    v_lshlrev_b32 v22, 16, v104
    v_and_b32 v23, s36, v104
    v_mul_f32 v22, s35, v22
    v_mul_f32 v23, s35, v23
    v_cvt_pk_bf16_f32 v104, v22, v23
    v_lshlrev_b32 v24, 16, v105
    v_and_b32 v25, s36, v105
    v_mul_f32 v24, s35, v24
    v_mul_f32 v25, s35, v25
    v_cvt_pk_bf16_f32 v105, v24, v25
    ds_write_b64 v6, v[104:105] offset:2176
    v_lshlrev_b32 v22, 16, v106
    v_and_b32 v23, s36, v106
    v_mul_f32 v22, s35, v22
    v_mul_f32 v23, s35, v23
    v_cvt_pk_bf16_f32 v106, v22, v23
    v_lshlrev_b32 v24, 16, v107
    v_and_b32 v25, s36, v107
    v_mul_f32 v24, s35, v24
    v_mul_f32 v25, s35, v25
    v_cvt_pk_bf16_f32 v107, v24, v25
    ds_write_b64 v6, v[106:107] offset:2184
    s_waitcnt vmcnt(0)
    v_lshlrev_b32 v22, 16, v108
    v_and_b32 v23, s36, v108
    v_mul_f32 v22, s35, v22
    v_mul_f32 v23, s35, v23
    v_cvt_pk_bf16_f32 v108, v22, v23
    v_lshlrev_b32 v24, 16, v109
    v_and_b32 v25, s36, v109
    v_mul_f32 v24, s35, v24
    v_mul_f32 v25, s35, v25
    v_cvt_pk_bf16_f32 v109, v24, v25
    ds_write_b64 v6, v[108:109] offset:3264
    v_lshlrev_b32 v22, 16, v110
    v_and_b32 v23, s36, v110
    v_mul_f32 v22, s35, v22
    v_mul_f32 v23, s35, v23
    v_cvt_pk_bf16_f32 v110, v22, v23
    v_lshlrev_b32 v24, 16, v111
    v_and_b32 v25, s36, v111
    v_mul_f32 v24, s35, v24
    v_mul_f32 v25, s35, v25
    v_cvt_pk_bf16_f32 v111, v24, v25
    ds_write_b64 v6, v[110:111] offset:3272
    ds_read_b128 a[32:35], v7 offset:0
    ds_read_b128 a[36:39], v7 offset:64
    ds_read_b128 a[40:43], v7 offset:128
    ds_read_b128 a[44:47], v7 offset:192
    v_mov_b32 v24, 0xff800000
    s_mov_b32 s76, 0
    s_waitcnt vmcnt(0) lgkmcnt(0)
    s_nop 7
    s_nop 7
Lslow_p1:
    s_add_u32 s77, s76, 4096
    buffer_load_dwordx4 a[128:131], v92, s[16:19], s76 offen offset:0
    buffer_load_dwordx4 a[132:135], v92, s[16:19], s76 offen offset:64
    buffer_load_dwordx4 a[136:139], v92, s[16:19], s76 offen offset:128
    buffer_load_dwordx4 a[140:143], v92, s[16:19], s76 offen offset:192
    buffer_load_dwordx4 a[144:147], v92, s[16:19], s77 offen offset:0
    buffer_load_dwordx4 a[148:151], v92, s[16:19], s77 offen offset:64
    buffer_load_dwordx4 a[152:155], v92, s[16:19], s77 offen offset:128
    buffer_load_dwordx4 a[156:159], v92, s[16:19], s77 offen offset:192
    s_waitcnt vmcnt(7)
    v_mfma_f32_16x16x32_bf16 v[36:39], a[128:131], a[32:35], 0
    s_waitcnt vmcnt(6)
    v_mfma_f32_16x16x32_bf16 v[36:39], a[132:135], a[36:39], v[36:39]
    s_waitcnt vmcnt(5)
    v_mfma_f32_16x16x32_bf16 v[36:39], a[136:139], a[40:43], v[36:39]
    s_waitcnt vmcnt(4)
    v_mfma_f32_16x16x32_bf16 v[36:39], a[140:143], a[44:47], v[36:39]
    s_waitcnt vmcnt(3)
    v_mfma_f32_16x16x32_bf16 v[40:43], a[144:147], a[32:35], 0
    s_waitcnt vmcnt(2)
    v_mfma_f32_16x16x32_bf16 v[40:43], a[148:151], a[36:39], v[40:43]
    s_waitcnt vmcnt(1)
    v_mfma_f32_16x16x32_bf16 v[40:43], a[152:155], a[40:43], v[40:43]
    s_waitcnt vmcnt(0)
    v_mfma_f32_16x16x32_bf16 v[40:43], a[156:159], a[44:47], v[40:43]
    v_max3_f32 v24, v24, v36, v37
    v_max3_f32 v24, v24, v38, v39
    s_nop 5
    v_max3_f32 v24, v24, v40, v41
    v_max3_f32 v24, v24, v42, v43
    s_add_u32 s76, s76, 8192
    s_waitcnt vmcnt(0) lgkmcnt(0)
    s_nop 7
    s_nop 7
    s_cmp_lt_u32 s76, 131072
    s_cbranch_scc1 Lslow_p1
    v_mov_b32 v23, v24
    s_nop 1
    v_permlane32_swap_b32 v24, v23
    v_max_f32 v24, v24, v23
    v_mov_b32 v23, v24
    s_nop 1
    v_permlane16_swap_b32 v24, v23
    v_max_f32 v24, v24, v23
    v_sub_f32 v24, 0, v24
    v_mov_b32 v68, v24
    v_mov_b32 v69, v24
    v_mov_b32 v70, v24
    v_mov_b32 v71, v24
    v_mov_b32 v128, 0
    v_mov_b32 v129, 0
    v_mov_b32 v130, 0
    v_mov_b32 v131, 0
    v_mov_b32 v132, 0
    v_mov_b32 v133, 0
    v_mov_b32 v134, 0
    v_mov_b32 v135, 0
    v_mov_b32 v136, 0
    v_mov_b32 v137, 0
    v_mov_b32 v138, 0
    v_mov_b32 v139, 0
    v_mov_b32 v140, 0
    v_mov_b32 v141, 0
    v_mov_b32 v142, 0
    v_mov_b32 v143, 0
    v_mov_b32 v144, 0
    v_mov_b32 v145, 0
    v_mov_b32 v146, 0
    v_mov_b32 v147, 0
    v_mov_b32 v148, 0
    v_mov_b32 v149, 0
    v_mov_b32 v150, 0
    v_mov_b32 v151, 0
    v_mov_b32 v152, 0
    v_mov_b32 v153, 0
    v_mov_b32 v154, 0
    v_mov_b32 v155, 0
    v_mov_b32 v156, 0
    v_mov_b32 v157, 0
    v_mov_b32 v158, 0
    v_mov_b32 v159, 0
    v_accvgpr_write_b32 a192, 0
    v_accvgpr_write_b32 a193, 0
    v_accvgpr_write_b32 a194, 0
    v_accvgpr_write_b32 a195, 0
    s_mov_b32 s76, 0
    s_waitcnt vmcnt(0) lgkmcnt(0)
    s_nop 7
    s_nop 7
Lslow_p2:
    s_add_u32 s77, s76, 4096
    buffer_load_dwordx4 a[128:131], v92, s[16:19], s76 offen offset:0
    buffer_load_dwordx4 a[132:135], v92, s[16:19], s76 offen offset:64
    buffer_load_dwordx4 a[136:139], v92, s[16:19], s76 offen offset:128
    buffer_load_dwordx4 a[140:143], v92, s[16:19], s76 offen offset:192
    buffer_load_dwordx4 a[144:147], v92, s[16:19], s77 offen offset:0
    buffer_load_dwordx4 a[148:151], v92, s[16:19], s77 offen offset:64
    buffer_load_dwordx4 a[152:155], v92, s[16:19], s77 offen offset:128
    buffer_load_dwordx4 a[156:159], v92, s[16:19], s77 offen offset:192
    s_add_u32 m0, s39, 0
    s_add_u32 s38, s76, 0
    buffer_load_dwordx4 v93, s[20:23], s38 offen offset:0 lds
    buffer_load_dwordx4 v94, s[20:23], s38 offen offset:1024 lds
    s_add_u32 m0, s39, 2048
    s_add_u32 s38, s76, 2048
    buffer_load_dwordx4 v93, s[20:23], s38 offen offset:0 lds
    buffer_load_dwordx4 v94, s[20:23], s38 offen offset:1024 lds
    s_add_u32 m0, s39, 4096
    s_add_u32 s38, s76, 4096
    buffer_load_dwordx4 v93, s[20:23], s38 offen offset:0 lds
    buffer_load_dwordx4 v94, s[20:23], s38 offen offset:1024 lds
    s_add_u32 m0, s39, 6144
    s_add_u32 s38, s76, 6144
    buffer_load_dwordx4 v93, s[20:23], s38 offen offset:0 lds
    buffer_load_dwordx4 v94, s[20:23], s38 offen offset:1024 lds
    s_waitcnt vmcnt(0) lgkmcnt(0)
    s_nop 7
    s_nop 7
    ds_read_b64_tr_b16 a[160:161], v13 offset:0
    ds_read_b64_tr_b16 a[162:163], v13 offset:4096
    ds_read_b64_tr_b16 a[164:165], v14 offset:0
    ds_read_b64_tr_b16 a[166:167], v14 offset:4096
    ds_read_b64_tr_b16 a[168:169], v15 offset:0
    ds_read_b64_tr_b16 a[170:171], v15 offset:4096
    ds_read_b64_tr_b16 a[172:173], v16 offset:0
    ds_read_b64_tr_b16 a[174:175], v16 offset:4096
    ds_read_b64_tr_b16 a[176:177], v17 offset:0
    ds_read_b64_tr_b16 a[178:179], v17 offset:4096
    ds_read_b64_tr_b16 a[180:181], v18 offset:0
    ds_read_b64_tr_b16 a[182:183], v18 offset:4096
    ds_read_b64_tr_b16 a[184:185], v19 offset:0
    ds_read_b64_tr_b16 a[186:187], v19 offset:4096
    ds_read_b64_tr_b16 a[188:189], v20 offset:0
    ds_read_b64_tr_b16 a[190:191], v20 offset:4096
    v_mfma_f32_16x16x32_bf16 v[36:39], a[128:131], a[32:35], v[68:71]
    v_mfma_f32_16x16x32_bf16 v[36:39], a[132:135], a[36:39], v[36:39]
    v_mfma_f32_16x16x32_bf16 v[36:39], a[136:139], a[40:43], v[36:39]
    v_mfma_f32_16x16x32_bf16 v[36:39], a[140:143], a[44:47], v[36:39]
    v_mfma_f32_16x16x32_bf16 v[40:43], a[144:147], a[32:35], v[68:71]
    v_mfma_f32_16x16x32_bf16 v[40:43], a[148:151], a[36:39], v[40:43]
    v_mfma_f32_16x16x32_bf16 v[40:43], a[152:155], a[40:43], v[40:43]
    v_mfma_f32_16x16x32_bf16 v[40:43], a[156:159], a[44:47], v[40:43]
    s_nop 3
    v_exp_f32 v36, v36
    v_exp_f32 v37, v37
    v_exp_f32 v38, v38
    v_exp_f32 v39, v39
    v_exp_f32 v40, v40
    v_exp_f32 v41, v41
    v_exp_f32 v42, v42
    v_exp_f32 v43, v43
    v_cvt_pk_bf16_f32 v36, v36, v37
    v_cvt_pk_bf16_f32 v37, v38, v39
    v_cvt_pk_bf16_f32 v38, v40, v41
    v_cvt_pk_bf16_f32 v39, v42, v43
    s_nop 1
    v_mfma_f32_16x16x32_bf16 a[192:195], a[216:219], v[36:39], a[192:195]
    s_waitcnt lgkmcnt(14)
    v_mfma_f32_16x16x32_bf16 v[128:131], a[160:163], v[36:39], v[128:131]
    s_waitcnt lgkmcnt(12)
    v_mfma_f32_16x16x32_bf16 v[132:135], a[164:167], v[36:39], v[132:135]
    s_waitcnt lgkmcnt(10)
    v_mfma_f32_16x16x32_bf16 v[136:139], a[168:171], v[36:39], v[136:139]
    s_waitcnt lgkmcnt(8)
    v_mfma_f32_16x16x32_bf16 v[140:143], a[172:175], v[36:39], v[140:143]
    s_waitcnt lgkmcnt(6)
    v_mfma_f32_16x16x32_bf16 v[144:147], a[176:179], v[36:39], v[144:147]
    s_waitcnt lgkmcnt(4)
    v_mfma_f32_16x16x32_bf16 v[148:151], a[180:183], v[36:39], v[148:151]
    s_waitcnt lgkmcnt(2)
    v_mfma_f32_16x16x32_bf16 v[152:155], a[184:187], v[36:39], v[152:155]
    s_waitcnt lgkmcnt(0)
    v_mfma_f32_16x16x32_bf16 v[156:159], a[188:191], v[36:39], v[156:159]
    s_add_u32 s76, s76, 8192
    s_waitcnt vmcnt(0) lgkmcnt(0)
    s_nop 7
    s_nop 7
    s_cmp_lt_u32 s76, 131072
    s_cbranch_scc1 Lslow_p2
    v_accvgpr_read_b32 v22, a192
    v_rcp_f32 v69, v22
    s_nop 0
    v_mul_f32 v128, v69, v128
    v_mul_f32 v129, v69, v129
    v_mul_f32 v130, v69, v130
    v_mul_f32 v131, v69, v131
    v_cvt_pk_bf16_f32 v128, v128, v129
    v_cvt_pk_bf16_f32 v129, v130, v131
    ds_write_b64 v8, v[128:129] offset:0
    v_mul_f32 v132, v69, v132
    v_mul_f32 v133, v69, v133
    v_mul_f32 v134, v69, v134
    v_mul_f32 v135, v69, v135
    v_cvt_pk_bf16_f32 v132, v132, v133
    v_cvt_pk_bf16_f32 v133, v134, v135
    ds_write_b64 v8, v[132:133] offset:32
    v_mul_f32 v136, v69, v136
    v_mul_f32 v137, v69, v137
    v_mul_f32 v138, v69, v138
    v_mul_f32 v139, v69, v139
    v_cvt_pk_bf16_f32 v136, v136, v137
    v_cvt_pk_bf16_f32 v137, v138, v139
    ds_write_b64 v8, v[136:137] offset:64
    v_mul_f32 v140, v69, v140
    v_mul_f32 v141, v69, v141
    v_mul_f32 v142, v69, v142
    v_mul_f32 v143, v69, v143
    v_cvt_pk_bf16_f32 v140, v140, v141
    v_cvt_pk_bf16_f32 v141, v142, v143
    ds_write_b64 v8, v[140:141] offset:96
    v_mul_f32 v144, v69, v144
    v_mul_f32 v145, v69, v145
    v_mul_f32 v146, v69, v146
    v_mul_f32 v147, v69, v147
    v_cvt_pk_bf16_f32 v144, v144, v145
    v_cvt_pk_bf16_f32 v145, v146, v147
    ds_write_b64 v8, v[144:145] offset:128
    v_mul_f32 v148, v69, v148
    v_mul_f32 v149, v69, v149
    v_mul_f32 v150, v69, v150
    v_mul_f32 v151, v69, v151
    v_cvt_pk_bf16_f32 v148, v148, v149
    v_cvt_pk_bf16_f32 v149, v150, v151
    ds_write_b64 v8, v[148:149] offset:160
    v_mul_f32 v152, v69, v152
    v_mul_f32 v153, v69, v153
    v_mul_f32 v154, v69, v154
    v_mul_f32 v155, v69, v155
    v_cvt_pk_bf16_f32 v152, v152, v153
    v_cvt_pk_bf16_f32 v153, v154, v155
    ds_write_b64 v8, v[152:153] offset:192
    v_mul_f32 v156, v69, v156
    v_mul_f32 v157, v69, v157
    v_mul_f32 v158, v69, v158
    v_mul_f32 v159, v69, v159
    v_cvt_pk_bf16_f32 v156, v156, v157
    v_cvt_pk_bf16_f32 v157, v158, v159
    ds_write_b64 v8, v[156:157] offset:224
    ds_read_b128 v[128:131], v6 offset:0
    ds_read_b128 v[132:135], v6 offset:1088
    ds_read_b128 v[136:139], v6 offset:2176
    ds_read_b128 v[140:143], v6 offset:3264
    s_waitcnt lgkmcnt(3)
    buffer_store_dwordx4 v[128:131], v1, s[24:27], s75 offen offset:0 nt
    s_waitcnt lgkmcnt(2)
    buffer_store_dwordx4 v[132:135], v1, s[24:27], s75 offen offset:1024 nt
    s_waitcnt lgkmcnt(1)
    buffer_store_dwordx4 v[136:139], v1, s[24:27], s75 offen offset:2048 nt
    s_waitcnt lgkmcnt(0)
    buffer_store_dwordx4 v[140:143], v1, s[24:27], s75 offen offset:3072 nt
    s_waitcnt vmcnt(0) lgkmcnt(0)
    s_nop 7
    s_nop 7
Lslow_next:
    s_mov_b64 s[62:63], s[64:65]
    s_mov_b64 s[64:65], s[66:67]
    s_mov_b64 s[66:67], s[68:69]
    s_mov_b64 s[68:69], s[70:71]
    s_mov_b64 s[70:71], s[72:73]
    s_add_u32 s75, s75, 16384
    s_add_u32 s74, s74, 1
    s_cmp_lt_u32 s74, 6
    s_cbranch_scc1 Lslow_tile
    s_endpgm
Lcode_end:
.section .rodata,"a"
.p2align 6
.amdhsa_kernel standalone__gqa_softmax__near_ridge_kernel
  .amdhsa_next_free_vgpr 512
  .amdhsa_next_free_sgpr 102
  .amdhsa_accum_offset 256
  .amdhsa_group_segment_fixed_size 0
  .amdhsa_kernarg_size 48
  .amdhsa_user_sgpr_count 2
  .amdhsa_user_sgpr_kernarg_segment_ptr 1
  .amdhsa_system_sgpr_workgroup_id_x 1
.end_amdhsa_kernel
```
